```python
import torch

def _softmax(x, axis=-1):
    return torch.softmax(x, dim=axis)
def _gelu(x):
    return torch.nn.functional.gelu(x, approximate="tanh")
def _silu(x):
    return torch.nn.functional.silu(x)
def _sigmoid(x):
    return torch.sigmoid(x)
def _layernorm(x, axis=-1, eps=1e-5):
    m = x.mean(dim=axis, keepdim=True)
    v = x.var(dim=axis, keepdim=True, unbiased=False)
    return (x - m) / torch.sqrt(v + eps)
def _scatter_add(tgt, idx, src, axis=0):
    return tgt.clone().index_add_(axis, idx, src)
def _segment_sum(src, seg, n):
    out = torch.zeros((n,) + src.shape[1:], dtype=src.dtype)
    return out.index_add_(0, seg, src)
def _pad(x, pw):
    flat = tuple(v for pair in reversed(pw) for v in pair)
    return torch.nn.functional.pad(x, flat)

kernel_name = 'concat_heads__ssm_conv_s4d__ssm_conv_s5__prompt'

def setup_inputs():

    _w = (lambda a: (lambda t: t.to(torch.bfloat16) if t.is_floating_point() else t)(torch.as_tensor(a)))
    def _A_setup():
        Bsz, L, D, N = 1, 2048, 448, 256
        return {
            "u": _w((lambda *s: torch.randn(*s, dtype=torch.bfloat16) * 0.05)(Bsz, L, D)),
            "log_A_real": _w((lambda *s: torch.randn(*s, dtype=torch.bfloat16) * 3.2)(D, N) * 0.5),
            "A_imag": _w((lambda *s: torch.randn(*s, dtype=torch.bfloat16) * 0.05)(D, N) * 3.14),
            "C_real": _w((lambda *s: torch.randn(*s, dtype=torch.bfloat16) * 0.1)(D, N) / N ** 0.5),
            "C_imag": _w((lambda *s: torch.randn(*s, dtype=torch.bfloat16) * 0.1)(D, N) / N ** 0.5),
            "log_dt": _w((lambda *s: torch.randn(*s, dtype=torch.bfloat16) * 0.05)(D) * 0.5 - 4.0),
            "D_skip": _w((lambda *s: torch.randn(*s, dtype=torch.bfloat16) * 0.05)(D)),
        }
    _A_in = _A_setup()

    def _B_setup():
        B, S, D = 1, 2048, 448
        P = D
        Lambda_re = -0.5 * (lambda _x: torch.exp(torch.as_tensor(_x)))((lambda *s: torch.randn(*s, dtype=torch.bfloat16) * 0.2)(P))
        Lambda_im = (lambda *s: torch.randn(*s, dtype=torch.bfloat16) * 0.4)(P) * 1.0
        B_re = (lambda *s: torch.randn(*s, dtype=torch.bfloat16) * 0.2)(P, D) * (D ** -0.5)
        B_im = (lambda *s: torch.randn(*s, dtype=torch.bfloat16) * 0.2)(P, D) * (D ** -0.5)
        C_re = (lambda *s: torch.randn(*s, dtype=torch.bfloat16) * 0.2)(D, P) * (P ** -0.5)
        C_im = (lambda *s: torch.randn(*s, dtype=torch.bfloat16) * 0.2)(D, P) * (P ** -0.5)
        log_dt = (lambda *s: torch.randn(*s, dtype=torch.bfloat16) * 0.2)(P) * 0.3 - 2.0
        Dskip = (lambda *s: torch.randn(*s, dtype=torch.bfloat16) * 0.05)(D)
        return {
            "x": _w((lambda *s: torch.randn(*s, dtype=torch.bfloat16) * 0.05)(B, S, D)),
            "Lambda_re": _w(Lambda_re),
            "Lambda_im": _w(Lambda_im),
            "B_re": _w(B_re),
            "B_im": _w(B_im),
            "C_re": _w(C_re),
            "C_im": _w(C_im),
            "log_dt": _w(log_dt),
            "Dskip": _w(Dskip),
        }
    _B_in = _B_setup()

    return {
        "A_u": _A_in["u"],
        "A_log_A_real": _A_in["log_A_real"],
        "A_A_imag": _A_in["A_imag"],
        "A_C_real": _A_in["C_real"],
        "A_C_imag": _A_in["C_imag"],
        "A_log_dt": _A_in["log_dt"],
        "A_D_skip": _A_in["D_skip"],
        "B_x": _B_in["x"],
        "B_Lambda_re": _B_in["Lambda_re"],
        "B_Lambda_im": _B_in["Lambda_im"],
        "B_B_re": _B_in["B_re"],
        "B_B_im": _B_in["B_im"],
        "B_C_re": _B_in["C_re"],
        "B_C_im": _B_in["C_im"],
        "B_log_dt": _B_in["log_dt"],
        "B_Dskip": _B_in["Dskip"],
    }

def reference(A_u, A_log_A_real, A_A_imag, A_C_real, A_C_imag, A_log_dt, A_D_skip, B_x, B_Lambda_re, B_Lambda_im, B_B_re, B_B_im, B_C_re, B_C_im, B_log_dt, B_Dskip):
    def _A_ref(u, log_A_real, A_imag, C_real, C_imag, log_dt, D_skip):
        L = u.shape[1]
        dt = torch.exp(log_dt)
        A = -torch.exp(log_A_real) + 1j * A_imag
        C = (C_real + 1j * C_imag) * dt[:, None]
        pos = (lambda x, dt: x.to(dt))(torch.arange(L), log_dt.dtype)
        P = torch.exp((A * dt[:, None])[:, :, None] * pos[None, None, :])
        K = 2.0 * torch.einsum("dn,dnl->dl", C, P).real
        L2 = 2 * L
        u_t = (lambda x, *d: x.permute(*d))(u, 0, 2, 1)
        Kf = (lambda x, *a, **k: torch.fft.rfft(x.float(), *a, **k))(K, L2)
        Uf = (lambda x, *a, **k: torch.fft.rfft(x.float(), *a, **k))(u_t, L2)
        y = (lambda x, *a, **k: torch.fft.irfft(x, *a, **k).to(torch.bfloat16))(Uf * Kf[None, :, :], L2)[:, :, :L]
        y = (lambda x, *d: x.permute(*d))(y, 0, 2, 1)
        return y + u * D_skip[None, None, :]

    def _B_ref(x, Lambda_re, Lambda_im, B_re, B_im, C_re, C_im, log_dt, Dskip):
        Bsz, L, H = x.shape
        Lam = Lambda_re + 1j * Lambda_im
        Bmat = B_re + 1j * B_im
        Cmat = C_re + 1j * C_im
        dt = torch.exp(log_dt)
        Lam_bar = torch.exp(dt * Lam)
        B_bar = ((Lam_bar - 1.0) / Lam)[:, None] * Bmat
        Bu = torch.einsum("bld,pd->blp", x + 0j, B_bar)
        h = torch.zeros_like(Bu[:, 0, :])
        hs = []
        for t in range(L):
            h = Lam_bar[None, :] * h + Bu[:, t, :]
            hs.append(h)
        hseq = torch.stack(hs, 1)
        y = 2.0 * torch.einsum("blp,dp->bld", hseq, Cmat).real + x * Dskip[None, None, :]
        return y

    a = _A_ref(A_u, A_log_A_real, A_A_imag, A_C_real, A_C_imag, A_log_dt, A_D_skip)
    b = _B_ref(B_x, B_Lambda_re, B_Lambda_im, B_B_re, B_B_im, B_C_re, B_C_im, B_log_dt, B_Dskip)
    return torch.concatenate([a, b], axis=-1)
```

```asm
; @launch grid=(512,1,1) block=(256,1,1) lds=81920
.amdgcn_target "amdgcn-amd-amdhsa--gfx950"
.text
.globl concat_heads__ssm_conv_s4d__ssm_conv_s5__prompt_kernel
.p2align 8
.type concat_heads__ssm_conv_s4d__ssm_conv_s5__prompt_kernel,@function
concat_heads__ssm_conv_s4d__ssm_conv_s5__prompt_kernel:
    s_cmp_ge_u32 s2, 256
    s_cselect_b32 s3, 56, 0
    s_load_dwordx16 s[16:31], s[0:1], s3
    s_load_dwordx8 s[32:39], s[0:1], 120
    v_lshrrev_b32 v30, 6, v0
    v_and_b32 v1, 63, v0
    s_getpc_b64 s[92:93]
L_pc:
    v_readfirstlane_b32 s9, v30
    s_bfe_u32 s4, s2, 0x50003
    s_cmp_lt_u32 s2, 480
    s_cbranch_scc1 L_nopf
    s_lshl_b32 s5, s4, 2
    s_add_u32 s5, s5, s9
    s_and_b32 s5, s5, 15
    s_mul_i32 s5, s5, 1536
    s_min_u32 s5, s5, L_end-L_pc-2048
    v_lshl_add_u32 v2, v1, 4, s5
    global_load_dwordx4 v[248:251], v2, s[92:93]
    global_load_dwordx4 v[252:255], v2, s[92:93] offset:1024
L_nopf:
    s_mov_b32 s98, 0x40000
    v_and_b32 v29, 0xff, v0
    s_cmp_lt_u32 s2, 256
    s_cbranch_scc1 A_entry
    s_cmp_ge_u32 s2, 512
    s_cbranch_scc1 L_exit
B_entry:
    s_and_b32 s3, s2, 7
    s_cmp_ge_u32 s4, 28
    s_cbranch_scc1 B_idle
    s_setprio 2
    s_mul_i32 s5, s4, 37
    s_lshr_b32 s5, s5, 8
    s_mul_i32 s14, s5, 7
    s_sub_u32 s6, s4, s14
    s_lshr_b32 s14, s3, 1
    s_and_b32 s14, s14, 2
    s_xor_b32 s3, s3, s14
    s_lshl_b32 s7, s3, 2
    s_add_u32 s7, s7, s5
    s_and_b32 s14, s5, 2
    s_lshl_b32 s14, s14, 1
    s_add_u32 s8, s6, s14
    s_sub_u32 s14, s8, 7
    s_cmp_ge_u32 s8, 7
    s_cselect_b32 s8, s14, s8
    s_lshl_b32 s8, s8, 7
    s_mul_i32 s12, s7, 57344
    s_mul_i32 s13, s6, 57344
    v_mov_b32 v15, 0
    s_and_b32 s10, s9, 1
    s_lshr_b32 s11, s9, 1
    s_mul_i32 s73, s9, 6144
    v_lshrrev_b32 v30, 3, v1
    s_lshl_b32 s14, s9, 4
    v_add_u32 v30, s14, v30
    v_mul_u32_u24 v30, 896, v30
    v_lshrrev_b32 v31, 4, v1
    v_and_b32 v2, 7, v1
    v_xor_b32 v31, v31, v2
    v_lshl_add_u32 v2, v31, 4, v30
    v_xor_b32 v31, 4, v31
    v_lshl_add_u32 v3, v31, 4, v30
    v_add_u32 v138, 8192, v3
    v_add_u32 v3, 10240, v3
    v_add_u32 v137, 2048, v2
    v_add_u32 v2, 4096, v2
    s_add_u32 s81, s12, s8
    s_add_u32 s88, s13, s8
    s_add_u32 s8, s8, 128
    s_cmp_eq_u32 s8, 896
    s_cselect_b32 s8, 0, s8
    v_and_b32 v30, 31, v1
    s_lshl_b32 s14, s6, 6
    s_lshl_b32 s15, s11, 5
    s_add_u32 s15, s15, s14
    v_add_lshl_u32 v30, v30, s15, 1
    v_and_b32 v31, 15, v1
    s_lshl_b32 s15, s9, 4
    s_add_u32 s15, s15, s14
    v_add_lshl_u32 v31, v31, s15, 1
    s_waitcnt lgkmcnt(0)
    global_load_ushort v140, v30, s[18:19]
    global_load_ushort v141, v30, s[20:21]
    global_load_ushort v146, v30, s[30:31]
    global_load_ushort v28, v31, s[32:33]
    s_sub_u32 s40, s16, 0x1000
    s_subb_u32 s41, s17, 0
    s_and_b32 s41, s41, 0xffff
    s_mov_b32 s42, 0x1c1000
    s_mov_b32 s43, 0x20000
    s_sub_u32 s44, s22, 0x1000
    s_subb_u32 s45, s23, 0
    s_and_b32 s45, s45, 0xffff
    s_mov_b32 s46, 0x63000
    s_mov_b32 s47, 0x20000
    s_sub_u32 s48, s24, 0x1000
    s_subb_u32 s49, s25, 0
    s_and_b32 s49, s49, 0xffff
    s_mov_b32 s50, 0x63000
    s_mov_b32 s51, 0x20000
    s_add_u32 m0, s73, 0
    s_nop 0
    buffer_load_dwordx4 v2, s[40:43], s81 offen lds
    buffer_load_dwordx4 v3, s[40:43], s81 offen offset:1024 lds
    buffer_load_dwordx4 v137, s[44:47], s88 offen offset:2048 lds
    buffer_load_dwordx4 v138, s[44:47], s88 offen offset:3072 lds
    s_add_u32 m0, m0, 4096
    s_nop 0
    buffer_load_dwordx4 v2, s[48:51], s88 offen lds
    buffer_load_dwordx4 v3, s[48:51], s88 offen offset:1024 lds
    s_branch B_rest
A_entry:
    s_and_b32 s5, s2, 7
    s_mov_b32 s6, s4
    s_cmp_eq_u32 s5, 7
    s_cbranch_scc1 A_idle
    s_setprio 3
    s_lshl_b32 s4, s5, 5
    s_add_u32 s4, s4, s6
    s_lshr_b32 s10, s9, 1
    s_and_b32 s11, s9, 1
    s_lshl_b32 s12, s6, 6
    s_lshl_b32 s13, s9, 4
    s_add_u32 s12, s12, s13
    s_mul_i32 s12, s12, 896
    s_lshl_b32 s13, s5, 7
    s_add_u32 s62, s12, s13
    v_lshrrev_b32 v26, 3, v1
    v_and_b32 v27, 7, v1
    v_mul_u32_u24 v244, 896, v26
    v_lshl_add_u32 v244, v27, 4, v244
    v_add_u32 v245, 6144, v244
    s_mul_i32 s63, s9, 14336
    s_mov_b32 m0, s63
    s_mul_i32 s68, s10, 4608
    s_lshl_b32 s13, s11, 11
    s_add_u32 s68, s68, s13
    s_add_u32 s68, s68, 59392
    s_lshl_b32 s12, s4, 10
    s_lshl_b32 s13, s9, 8
    s_add_u32 s12, s12, s13
    v_lshl_add_u32 v25, v1, 2, s12
    s_lshl_b32 s12, s4, 2
    s_waitcnt lgkmcnt(0)
    global_load_dword v4, v25, s[18:19]
    global_load_dword v5, v25, s[20:21]
    global_load_dword v6, v25, s[22:23]
    global_load_dword v7, v25, s[24:25]
    s_load_dword s52, s[26:27], s12
    s_load_dword s53, s[28:29], s12
    s_mov_b32 s64, s16
    s_and_b32 s65, s17, 0xffff
    s_mov_b32 s66, 0x1c0000
    s_mov_b32 s67, 0x20000
    s_mov_b32 m0, s68
    s_lshl_b32 s13, s4, 6
    buffer_load_dwordx4 v244, s[64:67], s62 offen lds
    buffer_load_dwordx4 v245, s[64:67], s62 offen offset:1024 lds
    s_mov_b32 m0, s63
    v_mov_b32 v2, 0
    v_lshrrev_b32 v30, 5, v1
    v_and_b32 v31, 31, v1
    v_and_b32 v26, 1, v1
    v_lshrrev_b32 v27, 1, v1
    v_lshlrev_b32 v22, 11, v27
    v_lshl_add_u32 v22, v26, 5, v22
    v_lshrrev_b32 v27, 3, v1
    v_lshlrev_b32 v28, 7, v27
    v_lshl_add_u32 v28, v26, 4, v28
    v_bfe_u32 v27, v1, 1, 1
    v_lshl_add_u32 v28, v27, 6, v28
    v_bfe_u32 v27, v1, 2, 1
    v_lshl_add_u32 v246, v27, 5, v28
    v_lshlrev_b32 v28, 10, v26
    v_bfe_u32 v27, v1, 2, 2
    v_lshl_add_u32 v28, v27, 7, v28
    v_lshrrev_b32 v27, 4, v1
    v_lshl_add_u32 v28, v27, 4, v28
    v_bfe_u32 v27, v1, 1, 1
    v_lshl_add_u32 v28, v27, 3, v28
    v_add_u32 v247, s68, v28
    s_lshl_b32 s12, s5, 18
    s_add_u32 s13, s12, 0x500000
    s_add_u32 s40, s38, s13
    s_addc_u32 s41, s39, 0
    s_and_b32 s41, s41, 0xffff
    s_mov_b32 s42, 0x40000
    s_mov_b32 s43, 0x20000
    s_lshl_b32 s12, s6, 13
    s_lshl_b32 s13, s9, 11
    s_add_u32 s12, s12, s13
    v_lshlrev_b32 v23, 4, v1
    buffer_load_dwordx4 v[248:251], v23, s[40:43], s12 offen
    buffer_load_dwordx4 v[252:255], v23, s[40:43], s12 offen offset:1024
    s_mov_b32 s48, s34
    s_and_b32 s49, s35, 0xffff
    s_mov_b32 s50, 0x700000
    s_mov_b32 s51, 0x20000
    s_getreg_b32 s58, hwreg(HW_REG_XCC_ID)
    v_lshlrev_b32 v26, 3, v29
    v_sub_u32 v26, 2047, v26
    v_mov_b32 v76, 34720
    v_subrev_u32 v72, 0, v26
    v_subrev_u32 v73, 1, v26
    v_cvt_f32_i32 v74, v72
    v_cvt_f32_i32 v75, v73
    v_cvt_pk_bf16_f32 v74, v74, v75
    v_lshrrev_b32 v75, 16, v74
    v_and_b32 v74, 0xffff, v74
    v_cmp_gt_i32 vcc, 128, v72
    v_subrev_u32 v74, 0x4280, v74
    v_cmp_gt_i32 s[56:57], 0, v72
    v_cndmask_b32 v74, v74, v72, vcc
    v_add_u32 v74, 34048, v74
    v_cndmask_b32 v74, v74, v76, s[56:57]
    v_lshlrev_b32 v8, 1, v74
    v_cmp_gt_i32 vcc, 128, v73
    v_subrev_u32 v75, 0x4280, v75
    v_cmp_gt_i32 s[56:57], 0, v73
    v_cndmask_b32 v75, v75, v73, vcc
    v_add_u32 v75, 34048, v75
    v_cndmask_b32 v75, v75, v76, s[56:57]
    v_lshlrev_b32 v9, 1, v75
    v_subrev_u32 v72, 2, v26
    v_subrev_u32 v73, 3, v26
    v_cvt_f32_i32 v74, v72
    v_cvt_f32_i32 v75, v73
    v_cvt_pk_bf16_f32 v74, v74, v75
    v_lshrrev_b32 v75, 16, v74
    v_and_b32 v74, 0xffff, v74
    v_cmp_gt_i32 vcc, 128, v72
    v_subrev_u32 v74, 0x4280, v74
    v_cmp_gt_i32 s[56:57], 0, v72
    v_cndmask_b32 v74, v74, v72, vcc
    v_add_u32 v74, 34048, v74
    v_cndmask_b32 v74, v74, v76, s[56:57]
    v_lshlrev_b32 v10, 1, v74
    v_cmp_gt_i32 vcc, 128, v73
    v_subrev_u32 v75, 0x4280, v75
    v_cmp_gt_i32 s[56:57], 0, v73
    v_cndmask_b32 v75, v75, v73, vcc
    v_add_u32 v75, 34048, v75
    v_cndmask_b32 v75, v75, v76, s[56:57]
    v_lshlrev_b32 v11, 1, v75
    v_subrev_u32 v72, 4, v26
    v_subrev_u32 v73, 5, v26
    v_cvt_f32_i32 v74, v72
    v_cvt_f32_i32 v75, v73
    v_cvt_pk_bf16_f32 v74, v74, v75
    v_lshrrev_b32 v75, 16, v74
    v_and_b32 v74, 0xffff, v74
    v_cmp_gt_i32 vcc, 128, v72
    v_subrev_u32 v74, 0x4280, v74
    v_cmp_gt_i32 s[56:57], 0, v72
    v_cndmask_b32 v74, v74, v72, vcc
    v_add_u32 v74, 34048, v74
    v_cndmask_b32 v74, v74, v76, s[56:57]
    v_lshlrev_b32 v12, 1, v74
    v_cmp_gt_i32 vcc, 128, v73
    v_subrev_u32 v75, 0x4280, v75
    v_cmp_gt_i32 s[56:57], 0, v73
    v_cndmask_b32 v75, v75, v73, vcc
    v_add_u32 v75, 34048, v75
    v_cndmask_b32 v75, v75, v76, s[56:57]
    v_lshlrev_b32 v13, 1, v75
    v_subrev_u32 v72, 6, v26
    v_subrev_u32 v73, 7, v26
    v_cvt_f32_i32 v74, v72
    v_cvt_f32_i32 v75, v73
    v_cvt_pk_bf16_f32 v74, v74, v75
    v_lshrrev_b32 v75, 16, v74
    v_and_b32 v74, 0xffff, v74
    v_cmp_gt_i32 vcc, 128, v72
    v_subrev_u32 v74, 0x4280, v74
    v_cmp_gt_i32 s[56:57], 0, v72
    v_cndmask_b32 v74, v74, v72, vcc
    v_add_u32 v74, 34048, v74
    v_cndmask_b32 v74, v74, v76, s[56:57]
    v_lshlrev_b32 v14, 1, v74
    v_cmp_gt_i32 vcc, 128, v73
    v_subrev_u32 v75, 0x4280, v75
    v_cmp_gt_i32 s[56:57], 0, v73
    v_cndmask_b32 v75, v75, v73, vcc
    v_add_u32 v75, 34048, v75
    v_cndmask_b32 v75, v75, v76, s[56:57]
    v_lshlrev_b32 v15, 1, v75
    v_subrev_u32 v72, 8, v26
    v_subrev_u32 v73, 9, v26
    v_cvt_f32_i32 v74, v72
    v_cvt_f32_i32 v75, v73
    v_cvt_pk_bf16_f32 v74, v74, v75
    v_lshrrev_b32 v75, 16, v74
    v_and_b32 v74, 0xffff, v74
    v_cmp_gt_i32 vcc, 128, v72
    v_subrev_u32 v74, 0x4280, v74
    v_cmp_gt_i32 s[56:57], 0, v72
    v_cndmask_b32 v74, v74, v72, vcc
    v_add_u32 v74, 34048, v74
    v_cndmask_b32 v74, v74, v76, s[56:57]
    v_lshlrev_b32 v16, 1, v74
    v_cmp_gt_i32 vcc, 128, v73
    v_subrev_u32 v75, 0x4280, v75
    v_cmp_gt_i32 s[56:57], 0, v73
    v_cndmask_b32 v75, v75, v73, vcc
    v_add_u32 v75, 34048, v75
    v_cndmask_b32 v75, v75, v76, s[56:57]
    v_lshlrev_b32 v17, 1, v75
    v_subrev_u32 v72, 10, v26
    v_subrev_u32 v73, 11, v26
    v_cvt_f32_i32 v74, v72
    v_cvt_f32_i32 v75, v73
    v_cvt_pk_bf16_f32 v74, v74, v75
    v_lshrrev_b32 v75, 16, v74
    v_and_b32 v74, 0xffff, v74
    v_cmp_gt_i32 vcc, 128, v72
    v_subrev_u32 v74, 0x4280, v74
    v_cmp_gt_i32 s[56:57], 0, v72
    v_cndmask_b32 v74, v74, v72, vcc
    v_add_u32 v74, 34048, v74
    v_cndmask_b32 v74, v74, v76, s[56:57]
    v_lshlrev_b32 v18, 1, v74
    v_mov_b32 v72, 0
    v_mov_b32 v73, 0
    v_mov_b32 v74, 0
    v_mov_b32 v75, 0
    v_mul_u32_u24 v76, 4608, v30
    v_lshl_add_u32 v76, v31, 4, v76
    ds_write_b128 v76, v[72:75] offset:58880
    v_mov_b32 v76, 69440
    ds_write_b32 v76, v72
    ds_write_b32 v76, v72 offset:1408
    v_mov_b32 v72, 0x3c00
    ds_write_addtid_b32 v72
    ds_write_addtid_b32 v72 offset:256
    v_and_b32 v224, 3, v31
    v_lshrrev_b32 v72, 2, v31
    v_add_u32 v73, 3, v72
    v_cmp_eq_u32 vcc, 0, v72
    s_nop 1
    v_cndmask_b32 v225, v73, 0, vcc
    v_lshrrev_b32 v72, 3, v31
    v_and_b32 v73, 7, v31
    v_lshlrev_b32 v73, 2, v73
    v_mov_b32 v74, 0x76543210
    v_mov_b32 v75, 0x40644020
    v_cmp_eq_u32 vcc, 1, v72
    s_nop 1
    v_cndmask_b32 v74, v74, v75, vcc
    v_mov_b32 v75, 0x0
    v_cmp_eq_u32 vcc, 2, v72
    s_nop 1
    v_cndmask_b32 v74, v74, v75, vcc
    v_bfe_u32 v74, v74, v73, 4
    v_add_u32 v226, 11, v74
    v_mov_b32 v74, 0x0
    v_mov_b32 v75, 0x33112211
    v_cmp_eq_u32 vcc, 1, v72
    s_nop 1
    v_cndmask_b32 v74, v74, v75, vcc
    v_mov_b32 v75, 0x760854
    v_cmp_eq_u32 vcc, 2, v72
    s_nop 1
    v_cndmask_b32 v74, v74, v75, vcc
    v_bfe_u32 v74, v74, v73, 4
    v_add_u32 v75, 18, v74
    v_cmp_eq_u32 vcc, 0, v74
    s_nop 1
    v_cndmask_b32 v227, v75, 0, vcc
    v_lshlrev_b32 v72, 4, v30
    v_add_u32 v72, s63, v72
    s_movk_i32 s57, 528
    v_mad_u32_u24 v224, v224, s57, v72
    v_mad_u32_u24 v225, v225, s57, v72
    v_mad_u32_u24 v226, v226, s57, v72
    v_mad_u32_u24 v227, v227, s57, v72
    v_lshlrev_b32 v23, 4, v1
    s_waitcnt lgkmcnt(0)
    s_lshl_b32 s13, s10, 4
    s_lshr_b32 s52, s52, s13
    s_lshl_b32 s52, s52, 16
    s_lshr_b32 s53, s53, s13
    s_lshl_b32 s53, s53, 16
    v_mov_b32 v21, 0x3fb8aa3b
    v_mul_f32 v21, s52, v21
    v_exp_f32 v21, v21
    s_lshl_b32 s12, s6, 13
    s_lshl_b32 s13, s9, 11
    s_add_u32 s12, s12, s13
    v_cvt_pk_bf16_f32 v21, v21, v21
    v_lshlrev_b32 v21, 16, v21
    s_waitcnt vmcnt(4)
    v_and_b32 v24, 0x7fff7fff, v6
    v_and_b32 v25, 0x7fff7fff, v7
    v_pk_max_u16 v24, v24, v25
    s_nop 0
    v_lshrrev_b32 v25, 16, v24
    v_and_b32 v24, 0xffff, v24
    v_max_u32 v24, v24, v25
    s_nop 1
    v_max_u32_dpp v24, v24, v24 row_shr:1 row_mask:0xf bank_mask:0xf
    s_nop 1
    v_max_u32_dpp v24, v24, v24 row_shr:2 row_mask:0xf bank_mask:0xf
    s_nop 1
    v_max_u32_dpp v24, v24, v24 row_shr:4 row_mask:0xf bank_mask:0xf
    s_nop 1
    v_max_u32_dpp v24, v24, v24 row_shr:8 row_mask:0xf bank_mask:0xf
    s_nop 1
    v_max_u32_dpp v24, v24, v24 row_bcast:15 row_mask:0xf bank_mask:0xf
    s_nop 1
    v_max_u32_dpp v24, v24, v24 row_bcast:31 row_mask:0xf bank_mask:0xf
    s_nop 0
    v_readlane_b32 s60, v24, 63
    v_add_f32 v19, v21, v21
    s_lshr_b32 s60, s60, 7
    s_max_u32 s60, s60, 20
    s_sub_u32 s61, s60, 12
    s_lshl_b32 s61, s61, 23
    s_sub_u32 s60, 266, s60
    s_lshl_b32 s60, s60, 23
    v_mul_f32 v19, s61, v19
    v_lshlrev_b32 v128, 16, v4
    v_lshlrev_b32 v129, 16, v5
    v_mul_f32 v128, 0x3fb8aa3b, v128
    v_mul_f32 v129, v129, v21
    v_exp_f32 v128, v128
    v_mul_f32 v129, 0.15915494, v129
    v_lshlrev_b32 v130, 16, v6
    v_cvt_pk_bf16_f32 v128, v128, v128
    v_mul_f32 v135, 0x41000000, v129
    v_mul_f32 v143, 0x43800000, v129
    v_lshlrev_b32 v128, 16, v128
    v_fract_f32 v135, v135
    v_fract_f32 v139, v129
    v_mul_f32 v128, v128, v21
    v_sin_f32 v133, v135
    v_cos_f32 v132, v135
    v_mul_f32 v128, 0xbfb8aa3b, v128
    v_fract_f32 v143, v143
    v_lshlrev_b32 v131, 16, v7
    v_mul_f32 v134, 0x41000000, v128
    v_mul_f32 v142, 0x43800000, v128
    v_exp_f32 v134, v134
    v_exp_f32 v138, v128
    v_cos_f32 v136, v139
    v_mul_f32 v133, v133, v134
    v_mul_f32 v132, v132, v134
    v_sin_f32 v137, v139
    v_mul_f32 v146, v133, v133
    v_cvt_pk_f16_f32 v73, v132, v133
    v_exp_f32 v142, v142
    ds_write_addtid_b32 v73 offset:528
    v_sin_f32 v141, v143
    v_mul_f32_e64 v145, v132, v133 mul:2
    v_fma_f32 v144, v132, v132, -v146
    v_mul_f32 v130, s60, v130
    v_cvt_pk_f16_f32 v74, v144, v145
    v_mul_f32 v131, s60, v131
    ds_write_addtid_b32 v74 offset:1056
    v_cvt_pk_f16_f32 v72, v130, -v131
    v_mul_f32 v136, v136, v138
    ds_write_addtid_b32 v72 offset:5808
    v_mul_f32 v137, v137, v138
    v_cos_f32 v140, v143
    v_mul_f32 v141, v141, v142
    v_mul_f32 v149, v145, v145
    v_mul_f32_e64 v148, v144, v145 mul:2
    v_mul_f32 v140, v140, v142
    v_fma_f32 v147, v144, v144, -v149
    v_mul_f32 v152, v148, v148
    v_cvt_pk_f16_f32 v75, v147, v148
    v_cvt_pk_f16_f32 v78, v140, -v141
    ds_write_addtid_b32 v75 offset:2112
    ds_write_addtid_b32 v78 offset:10032
    v_cvt_pk_f16_f32 v156, v136, -v137
    v_mul_f32 v159, v137, v137
    v_mul_f32 v167, v141, v141
    v_mul_f32_e64 v151, v147, v148 mul:2
    v_fma_f32 v150, v147, v147, -v152
    v_mul_f32_e64 v158, v136, v137 mul:2
    v_cvt_pk_f16_f32 v76, v150, v151
    v_fma_f32 v157, v136, v136, -v159
    ds_write_addtid_b32 v76 offset:2640
    v_mul_f32_e64 v166, v140, v141 mul:2
    v_fma_f32 v165, v140, v140, -v167
    v_pk_mul_f16 v86, v72, v156 op_sel:[0,0] op_sel_hi:[0,1]
    v_cvt_pk_f16_f32 v79, v165, -v166
    v_mul_f32 v155, v151, v151
    ds_write_addtid_b32 v79 offset:10560
    v_cvt_pk_f16_f32 v160, v157, -v158
    v_mul_f32 v163, v158, v158
    v_mul_f32 v170, v166, v166
    v_pk_fma_f16 v86, v72, v156, v86 op_sel:[1,1,0] op_sel_hi:[1,0,1] neg_lo:[1,0,0]
    v_mul_f32_e64 v154, v150, v151 mul:2
    ds_write_addtid_b32 v86 offset:6336
    v_fma_f32 v153, v150, v150, -v155
    v_mul_f32_e64 v162, v157, v158 mul:2
    v_cvt_pk_f16_f32 v77, v153, v154
    v_fma_f32 v161, v157, v157, -v163
    ds_write_addtid_b32 v77 offset:3696
    v_mul_f32_e64 v169, v165, v166 mul:2
    v_fma_f32 v168, v165, v165, -v170
    v_pk_mul_f16 v82, v75, v76 op_sel:[0,0] op_sel_hi:[0,1]
    v_cvt_pk_f16_f32 v80, v168, -v169
    v_pk_mul_f16 v87, v72, v160 op_sel:[0,0] op_sel_hi:[0,1]
    ds_write_addtid_b32 v80 offset:11616
    v_pk_mul_f16 v88, v86, v160 op_sel:[0,0] op_sel_hi:[0,1]
    v_pk_mul_f16 v93, v78, v79 op_sel:[0,0] op_sel_hi:[0,1]
    v_cvt_pk_f16_f32 v164, v161, -v162
    v_pk_fma_f16 v82, v75, v76, v82 op_sel:[1,1,0] op_sel_hi:[1,0,1] neg_lo:[1,0,0]
    v_pk_fma_f16 v87, v72, v160, v87 op_sel:[1,1,0] op_sel_hi:[1,0,1] neg_lo:[1,0,0]
    ds_write_addtid_b32 v82 offset:3168
    ds_write_addtid_b32 v87 offset:6864
    v_pk_fma_f16 v88, v86, v160, v88 op_sel:[1,1,0] op_sel_hi:[1,0,1] neg_lo:[1,0,0]
    v_pk_fma_f16 v93, v78, v79, v93 op_sel:[1,1,0] op_sel_hi:[1,0,1] neg_lo:[1,0,0]
    ds_write_addtid_b32 v88 offset:7392
    ds_write_addtid_b32 v93 offset:11088
    v_pk_mul_f16 v81, v73, v74 op_sel:[0,0] op_sel_hi:[0,1]
    v_pk_mul_f16 v83, v75, v77 op_sel:[0,0] op_sel_hi:[0,1]
    v_pk_mul_f16 v84, v76, v77 op_sel:[0,0] op_sel_hi:[0,1]
    v_pk_mul_f16 v85, v82, v77 op_sel:[0,0] op_sel_hi:[0,1]
    v_pk_mul_f16 v89, v72, v164 op_sel:[0,0] op_sel_hi:[0,1]
    v_pk_mul_f16 v90, v86, v164 op_sel:[0,0] op_sel_hi:[0,1]
    v_pk_mul_f16 v91, v87, v164 op_sel:[0,0] op_sel_hi:[0,1]
    v_pk_mul_f16 v92, v88, v164 op_sel:[0,0] op_sel_hi:[0,1]
    v_pk_mul_f16 v94, v78, v80 op_sel:[0,0] op_sel_hi:[0,1]
    v_pk_mul_f16 v95, v79, v80 op_sel:[0,0] op_sel_hi:[0,1]
    v_pk_mul_f16 v96, v93, v80 op_sel:[0,0] op_sel_hi:[0,1]
    v_pk_mul_f16 v97, v80, v80 op_sel:[0,0] op_sel_hi:[0,1]
    v_pk_fma_f16 v81, v73, v74, v81 op_sel:[1,1,0] op_sel_hi:[1,0,1] neg_lo:[1,0,0]
    v_pk_fma_f16 v83, v75, v77, v83 op_sel:[1,1,0] op_sel_hi:[1,0,1] neg_lo:[1,0,0]
    ds_write_addtid_b32 v81 offset:1584
    ds_write_addtid_b32 v83 offset:4224
    v_pk_fma_f16 v84, v76, v77, v84 op_sel:[1,1,0] op_sel_hi:[1,0,1] neg_lo:[1,0,0]
    v_pk_fma_f16 v85, v82, v77, v85 op_sel:[1,1,0] op_sel_hi:[1,0,1] neg_lo:[1,0,0]
    ds_write_addtid_b32 v84 offset:4752
    ds_write_addtid_b32 v85 offset:5280
    v_pk_fma_f16 v89, v72, v164, v89 op_sel:[1,1,0] op_sel_hi:[1,0,1] neg_lo:[1,0,0]
    v_pk_fma_f16 v90, v86, v164, v90 op_sel:[1,1,0] op_sel_hi:[1,0,1] neg_lo:[1,0,0]
    ds_write_addtid_b32 v89 offset:7920
    ds_write_addtid_b32 v90 offset:8448
    v_pk_fma_f16 v91, v87, v164, v91 op_sel:[1,1,0] op_sel_hi:[1,0,1] neg_lo:[1,0,0]
    v_pk_fma_f16 v92, v88, v164, v92 op_sel:[1,1,0] op_sel_hi:[1,0,1] neg_lo:[1,0,0]
    ds_write_addtid_b32 v91 offset:8976
    ds_write_addtid_b32 v92 offset:9504
    v_pk_fma_f16 v94, v78, v80, v94 op_sel:[1,1,0] op_sel_hi:[1,0,1] neg_lo:[1,0,0]
    v_pk_fma_f16 v95, v79, v80, v95 op_sel:[1,1,0] op_sel_hi:[1,0,1] neg_lo:[1,0,0]
    ds_write_addtid_b32 v94 offset:12144
    ds_write_addtid_b32 v95 offset:12672
    v_pk_fma_f16 v96, v93, v80, v96 op_sel:[1,1,0] op_sel_hi:[1,0,1] neg_lo:[1,0,0]
    v_pk_fma_f16 v97, v80, v80, v97 op_sel:[1,1,0] op_sel_hi:[1,0,1] neg_lo:[1,0,0]
    ds_write_addtid_b32 v96 offset:13200
    ds_write_addtid_b32 v97 offset:13728
    v_and_b32 v176, 0xffff0000, v4
    v_and_b32 v177, 0xffff0000, v5
    v_mul_f32 v176, 0x3fb8aa3b, v176
    v_mul_f32 v177, v177, v21
    v_exp_f32 v176, v176
    v_mul_f32 v177, 0.15915494, v177
    v_and_b32 v178, 0xffff0000, v6
    v_cvt_pk_bf16_f32 v176, v176, v176
    v_mul_f32 v183, 0x41000000, v177
    v_mul_f32 v191, 0x43800000, v177
    v_lshlrev_b32 v176, 16, v176
    v_fract_f32 v183, v183
    v_fract_f32 v187, v177
    v_mul_f32 v176, v176, v21
    v_sin_f32 v181, v183
    v_cos_f32 v180, v183
    v_mul_f32 v176, 0xbfb8aa3b, v176
    v_fract_f32 v191, v191
    v_and_b32 v179, 0xffff0000, v7
    v_mul_f32 v182, 0x41000000, v176
    v_mul_f32 v190, 0x43800000, v176
    v_exp_f32 v182, v182
    v_exp_f32 v186, v176
    v_cos_f32 v184, v187
    v_mul_f32 v181, v181, v182
    v_mul_f32 v180, v180, v182
    v_sin_f32 v185, v187
    v_mul_f32 v194, v181, v181
    v_cvt_pk_f16_f32 v99, v180, v181
    v_exp_f32 v190, v190
    ds_write_addtid_b32 v99 offset:784
    v_sin_f32 v189, v191
    v_mul_f32_e64 v193, v180, v181 mul:2
    v_fma_f32 v192, v180, v180, -v194
    v_mul_f32 v178, s60, v178
    v_cvt_pk_f16_f32 v100, v192, v193
    v_mul_f32 v179, s60, v179
    ds_write_addtid_b32 v100 offset:1312
    v_cvt_pk_f16_f32 v98, v178, -v179
    v_mul_f32 v184, v184, v186
    ds_write_addtid_b32 v98 offset:6064
    v_mul_f32 v185, v185, v186
    v_cos_f32 v188, v191
    v_mul_f32 v189, v189, v190
    v_mul_f32 v197, v193, v193
    v_mul_f32_e64 v196, v192, v193 mul:2
    v_mul_f32 v188, v188, v190
    v_fma_f32 v195, v192, v192, -v197
    v_mul_f32 v200, v196, v196
    v_cvt_pk_f16_f32 v101, v195, v196
    v_cvt_pk_f16_f32 v104, v188, -v189
    ds_write_addtid_b32 v101 offset:2368
    ds_write_addtid_b32 v104 offset:10288
    v_cvt_pk_f16_f32 v204, v184, -v185
    v_mul_f32 v207, v185, v185
    v_mul_f32 v215, v189, v189
    v_mul_f32_e64 v199, v195, v196 mul:2
    v_fma_f32 v198, v195, v195, -v200
    v_mul_f32_e64 v206, v184, v185 mul:2
    v_cvt_pk_f16_f32 v102, v198, v199
    v_fma_f32 v205, v184, v184, -v207
    ds_write_addtid_b32 v102 offset:2896
    v_mul_f32_e64 v214, v188, v189 mul:2
    v_fma_f32 v213, v188, v188, -v215
    v_pk_mul_f16 v112, v98, v204 op_sel:[0,0] op_sel_hi:[0,1]
    v_cvt_pk_f16_f32 v105, v213, -v214
    v_mul_f32 v203, v199, v199
    ds_write_addtid_b32 v105 offset:10816
    v_cvt_pk_f16_f32 v208, v205, -v206
    v_mul_f32 v211, v206, v206
    v_mul_f32 v218, v214, v214
    v_pk_fma_f16 v112, v98, v204, v112 op_sel:[1,1,0] op_sel_hi:[1,0,1] neg_lo:[1,0,0]
    v_mul_f32_e64 v202, v198, v199 mul:2
    ds_write_addtid_b32 v112 offset:6592
    v_fma_f32 v201, v198, v198, -v203
    v_mul_f32_e64 v210, v205, v206 mul:2
    v_cvt_pk_f16_f32 v103, v201, v202
    v_fma_f32 v209, v205, v205, -v211
    ds_write_addtid_b32 v103 offset:3952
    v_mul_f32_e64 v217, v213, v214 mul:2
    v_fma_f32 v216, v213, v213, -v218
    v_pk_mul_f16 v108, v101, v102 op_sel:[0,0] op_sel_hi:[0,1]
    v_cvt_pk_f16_f32 v106, v216, -v217
    v_pk_mul_f16 v113, v98, v208 op_sel:[0,0] op_sel_hi:[0,1]
    ds_write_addtid_b32 v106 offset:11872
    v_pk_mul_f16 v114, v112, v208 op_sel:[0,0] op_sel_hi:[0,1]
    v_pk_mul_f16 v119, v104, v105 op_sel:[0,0] op_sel_hi:[0,1]
    v_cvt_pk_f16_f32 v212, v209, -v210
    v_pk_fma_f16 v108, v101, v102, v108 op_sel:[1,1,0] op_sel_hi:[1,0,1] neg_lo:[1,0,0]
    v_pk_fma_f16 v113, v98, v208, v113 op_sel:[1,1,0] op_sel_hi:[1,0,1] neg_lo:[1,0,0]
    ds_write_addtid_b32 v108 offset:3424
    ds_write_addtid_b32 v113 offset:7120
    v_pk_fma_f16 v114, v112, v208, v114 op_sel:[1,1,0] op_sel_hi:[1,0,1] neg_lo:[1,0,0]
    v_pk_fma_f16 v119, v104, v105, v119 op_sel:[1,1,0] op_sel_hi:[1,0,1] neg_lo:[1,0,0]
    ds_write_addtid_b32 v114 offset:7648
    ds_write_addtid_b32 v119 offset:11344
    v_pk_mul_f16 v107, v99, v100 op_sel:[0,0] op_sel_hi:[0,1]
    v_pk_mul_f16 v109, v101, v103 op_sel:[0,0] op_sel_hi:[0,1]
    v_pk_mul_f16 v110, v102, v103 op_sel:[0,0] op_sel_hi:[0,1]
    v_pk_mul_f16 v111, v108, v103 op_sel:[0,0] op_sel_hi:[0,1]
    v_pk_mul_f16 v115, v98, v212 op_sel:[0,0] op_sel_hi:[0,1]
    v_pk_mul_f16 v116, v112, v212 op_sel:[0,0] op_sel_hi:[0,1]
    v_pk_mul_f16 v117, v113, v212 op_sel:[0,0] op_sel_hi:[0,1]
    v_pk_mul_f16 v118, v114, v212 op_sel:[0,0] op_sel_hi:[0,1]
    v_pk_mul_f16 v120, v104, v106 op_sel:[0,0] op_sel_hi:[0,1]
    v_pk_mul_f16 v121, v105, v106 op_sel:[0,0] op_sel_hi:[0,1]
    v_pk_mul_f16 v122, v119, v106 op_sel:[0,0] op_sel_hi:[0,1]
    v_pk_mul_f16 v123, v106, v106 op_sel:[0,0] op_sel_hi:[0,1]
    v_pk_fma_f16 v107, v99, v100, v107 op_sel:[1,1,0] op_sel_hi:[1,0,1] neg_lo:[1,0,0]
    v_pk_fma_f16 v109, v101, v103, v109 op_sel:[1,1,0] op_sel_hi:[1,0,1] neg_lo:[1,0,0]
    ds_write_addtid_b32 v107 offset:1840
    ds_write_addtid_b32 v109 offset:4480
    v_pk_fma_f16 v110, v102, v103, v110 op_sel:[1,1,0] op_sel_hi:[1,0,1] neg_lo:[1,0,0]
    v_pk_fma_f16 v111, v108, v103, v111 op_sel:[1,1,0] op_sel_hi:[1,0,1] neg_lo:[1,0,0]
    ds_write_addtid_b32 v110 offset:5008
    ds_write_addtid_b32 v111 offset:5536
    v_pk_fma_f16 v115, v98, v212, v115 op_sel:[1,1,0] op_sel_hi:[1,0,1] neg_lo:[1,0,0]
    v_pk_fma_f16 v116, v112, v212, v116 op_sel:[1,1,0] op_sel_hi:[1,0,1] neg_lo:[1,0,0]
    ds_write_addtid_b32 v115 offset:8176
    ds_write_addtid_b32 v116 offset:8704
    v_pk_fma_f16 v117, v113, v212, v117 op_sel:[1,1,0] op_sel_hi:[1,0,1] neg_lo:[1,0,0]
    v_pk_fma_f16 v118, v114, v212, v118 op_sel:[1,1,0] op_sel_hi:[1,0,1] neg_lo:[1,0,0]
    ds_write_addtid_b32 v117 offset:9232
    ds_write_addtid_b32 v118 offset:9760
    v_pk_fma_f16 v120, v104, v106, v120 op_sel:[1,1,0] op_sel_hi:[1,0,1] neg_lo:[1,0,0]
    v_pk_fma_f16 v121, v105, v106, v121 op_sel:[1,1,0] op_sel_hi:[1,0,1] neg_lo:[1,0,0]
    ds_write_addtid_b32 v120 offset:12400
    ds_write_addtid_b32 v121 offset:12928
    v_pk_fma_f16 v122, v119, v106, v122 op_sel:[1,1,0] op_sel_hi:[1,0,1] neg_lo:[1,0,0]
    v_pk_fma_f16 v123, v106, v106, v123 op_sel:[1,1,0] op_sel_hi:[1,0,1] neg_lo:[1,0,0]
    ds_write_addtid_b32 v122 offset:13456
    ds_write_addtid_b32 v123 offset:13984
    s_setprio 3
    ds_read_b128 v[64:67], v224 offset:0
    ds_read_b128 v[68:71], v225 offset:0
    ds_read_b128 v[72:75], v226 offset:0
    ds_read_b128 v[76:79], v227 offset:0
    ds_read_b128 v[80:83], v224 offset:32
    ds_read_b128 v[84:87], v225 offset:32
    ds_read_b128 v[88:91], v226 offset:32
    ds_read_b128 v[92:95], v227 offset:32
    ds_read_b128 v[96:99], v224 offset:64
    ds_read_b128 v[100:103], v225 offset:64
    ds_read_b128 v[104:107], v226 offset:64
    ds_read_b128 v[108:111], v227 offset:64
    s_waitcnt lgkmcnt(8)
    v_pk_mul_f16 v128, v64, v68 op_sel:[0,0] op_sel_hi:[0,1]
    ds_read_b128 v[112:115], v224 offset:96
    v_pk_mul_f16 v129, v65, v69 op_sel:[0,0] op_sel_hi:[0,1]
    v_pk_mul_f16 v130, v66, v70 op_sel:[0,0] op_sel_hi:[0,1]
    v_pk_mul_f16 v131, v67, v71 op_sel:[0,0] op_sel_hi:[0,1]
    v_pk_mul_f16 v132, v72, v76 op_sel:[0,0] op_sel_hi:[0,1]
    ds_read_b128 v[116:119], v225 offset:96
    v_pk_mul_f16 v133, v73, v77 op_sel:[0,0] op_sel_hi:[0,1]
    v_pk_mul_f16 v134, v74, v78 op_sel:[0,0] op_sel_hi:[0,1]
    v_pk_mul_f16 v135, v75, v79 op_sel:[0,0] op_sel_hi:[0,1]
    v_pk_fma_f16 v128, v64, v68, v128 op_sel:[1,1,0] op_sel_hi:[1,0,1] neg_lo:[1,0,0]
    ds_read_b128 v[120:123], v226 offset:96
    v_pk_fma_f16 v129, v65, v69, v129 op_sel:[1,1,0] op_sel_hi:[1,0,1] neg_lo:[1,0,0]
    v_pk_fma_f16 v130, v66, v70, v130 op_sel:[1,1,0] op_sel_hi:[1,0,1] neg_lo:[1,0,0]
    v_pk_fma_f16 v131, v67, v71, v131 op_sel:[1,1,0] op_sel_hi:[1,0,1] neg_lo:[1,0,0]
    v_pk_fma_f16 v132, v72, v76, v132 op_sel:[1,1,0] op_sel_hi:[1,0,1] neg_lo:[1,0,0]
    ds_read_b128 v[124:127], v227 offset:96
    v_pk_fma_f16 v133, v73, v77, v133 op_sel:[1,1,0] op_sel_hi:[1,0,1] neg_lo:[1,0,0]
    v_pk_fma_f16 v134, v74, v78, v134 op_sel:[1,1,0] op_sel_hi:[1,0,1] neg_lo:[1,0,0]
    v_pk_fma_f16 v135, v75, v79, v135 op_sel:[1,1,0] op_sel_hi:[1,0,1] neg_lo:[1,0,0]
    global_load_dword v3, v2, s[36:37] sc1
    s_lshl_b32 s69, s6, 13
    s_lshl_b32 s13, s9, 11
    s_add_u32 s69, s69, s13
    s_lshl_b32 s12, s5, 11
    s_add_u32 s12, s12, 0x9000
    v_lshl_add_u32 v242, v31, 6, s12
    s_waitcnt vmcnt(1)
    ds_read_b64_tr_b16 v[232:233], v247 offset:0
    ds_read_b64_tr_b16 v[234:235], v247 offset:512
    ds_read_b64_tr_b16 v[236:237], v247 offset:64
    ds_read_b64_tr_b16 v[238:239], v247 offset:576
    s_waitcnt lgkmcnt(0)
    buffer_store_dwordx4 v[232:235], v246, s[40:43], s69 offen
    buffer_store_dwordx4 v[236:239], v246, s[40:43], s69 offen offset:1024
    s_waitcnt lgkmcnt(8)
    v_pk_mul_f16 v136, v80, v84 op_sel:[0,0] op_sel_hi:[0,1]
    ds_read_b128 v[64:67], v224 offset:128
    v_pk_mul_f16 v137, v81, v85 op_sel:[0,0] op_sel_hi:[0,1]
    v_pk_mul_f16 v138, v82, v86 op_sel:[0,0] op_sel_hi:[0,1]
    v_pk_mul_f16 v139, v83, v87 op_sel:[0,0] op_sel_hi:[0,1]
    v_pk_mul_f16 v140, v88, v92 op_sel:[0,0] op_sel_hi:[0,1]
    ds_read_b128 v[68:71], v225 offset:128
    v_pk_mul_f16 v141, v89, v93 op_sel:[0,0] op_sel_hi:[0,1]
    v_mfma_f32_32x32x16_f16 v[32:47], v[132:135], v[128:131], 0
    v_pk_mul_f16 v142, v90, v94 op_sel:[0,0] op_sel_hi:[0,1]
    v_pk_mul_f16 v143, v91, v95 op_sel:[0,0] op_sel_hi:[0,1]
    v_pk_fma_f16 v136, v80, v84, v136 op_sel:[1,1,0] op_sel_hi:[1,0,1] neg_lo:[1,0,0]
    ds_read_b128 v[72:75], v226 offset:128
    v_pk_fma_f16 v137, v81, v85, v137 op_sel:[1,1,0] op_sel_hi:[1,0,1] neg_lo:[1,0,0]
    v_pk_fma_f16 v138, v82, v86, v138 op_sel:[1,1,0] op_sel_hi:[1,0,1] neg_lo:[1,0,0]
    v_pk_fma_f16 v139, v83, v87, v139 op_sel:[1,1,0] op_sel_hi:[1,0,1] neg_lo:[1,0,0]
    v_pk_fma_f16 v140, v88, v92, v140 op_sel:[1,1,0] op_sel_hi:[1,0,1] neg_lo:[1,0,0]
    ds_read_b128 v[76:79], v227 offset:128
    v_pk_fma_f16 v141, v89, v93, v141 op_sel:[1,1,0] op_sel_hi:[1,0,1] neg_lo:[1,0,0]
    v_pk_fma_f16 v142, v90, v94, v142 op_sel:[1,1,0] op_sel_hi:[1,0,1] neg_lo:[1,0,0]
    v_pk_fma_f16 v143, v91, v95, v143 op_sel:[1,1,0] op_sel_hi:[1,0,1] neg_lo:[1,0,0]
    s_waitcnt lgkmcnt(8)
    v_pk_mul_f16 v144, v96, v100 op_sel:[0,0] op_sel_hi:[0,1]
    ds_read_b128 v[80:83], v224 offset:160
    v_pk_mul_f16 v145, v97, v101 op_sel:[0,0] op_sel_hi:[0,1]
    v_pk_mul_f16 v146, v98, v102 op_sel:[0,0] op_sel_hi:[0,1]
    v_pk_mul_f16 v147, v99, v103 op_sel:[0,0] op_sel_hi:[0,1]
    v_pk_mul_f16 v148, v104, v108 op_sel:[0,0] op_sel_hi:[0,1]
    ds_read_b128 v[84:87], v225 offset:160
    v_pk_mul_f16 v149, v105, v109 op_sel:[0,0] op_sel_hi:[0,1]
    v_mfma_f32_32x32x16_f16 v[32:47], v[140:143], v[136:139], v[32:47]
    v_pk_mul_f16 v150, v106, v110 op_sel:[0,0] op_sel_hi:[0,1]
    v_pk_mul_f16 v151, v107, v111 op_sel:[0,0] op_sel_hi:[0,1]
    v_pk_fma_f16 v144, v96, v100, v144 op_sel:[1,1,0] op_sel_hi:[1,0,1] neg_lo:[1,0,0]
    ds_read_b128 v[88:91], v226 offset:160
    v_pk_fma_f16 v145, v97, v101, v145 op_sel:[1,1,0] op_sel_hi:[1,0,1] neg_lo:[1,0,0]
    v_pk_fma_f16 v146, v98, v102, v146 op_sel:[1,1,0] op_sel_hi:[1,0,1] neg_lo:[1,0,0]
    v_pk_fma_f16 v147, v99, v103, v147 op_sel:[1,1,0] op_sel_hi:[1,0,1] neg_lo:[1,0,0]
    v_pk_fma_f16 v148, v104, v108, v148 op_sel:[1,1,0] op_sel_hi:[1,0,1] neg_lo:[1,0,0]
    ds_read_b128 v[92:95], v227 offset:160
    v_pk_fma_f16 v149, v105, v109, v149 op_sel:[1,1,0] op_sel_hi:[1,0,1] neg_lo:[1,0,0]
    v_pk_fma_f16 v150, v106, v110, v150 op_sel:[1,1,0] op_sel_hi:[1,0,1] neg_lo:[1,0,0]
    v_pk_fma_f16 v151, v107, v111, v151 op_sel:[1,1,0] op_sel_hi:[1,0,1] neg_lo:[1,0,0]
    s_waitcnt lgkmcnt(8)
    v_pk_mul_f16 v152, v112, v116 op_sel:[0,0] op_sel_hi:[0,1]
    ds_read_b128 v[96:99], v224 offset:192
    v_pk_mul_f16 v153, v113, v117 op_sel:[0,0] op_sel_hi:[0,1]
    v_pk_mul_f16 v154, v114, v118 op_sel:[0,0] op_sel_hi:[0,1]
    v_pk_mul_f16 v155, v115, v119 op_sel:[0,0] op_sel_hi:[0,1]
    v_pk_mul_f16 v156, v120, v124 op_sel:[0,0] op_sel_hi:[0,1]
    ds_read_b128 v[100:103], v225 offset:192
    v_pk_mul_f16 v157, v121, v125 op_sel:[0,0] op_sel_hi:[0,1]
    v_mfma_f32_32x32x16_f16 v[32:47], v[148:151], v[144:147], v[32:47]
    v_pk_mul_f16 v158, v122, v126 op_sel:[0,0] op_sel_hi:[0,1]
    v_pk_mul_f16 v159, v123, v127 op_sel:[0,0] op_sel_hi:[0,1]
    v_pk_fma_f16 v152, v112, v116, v152 op_sel:[1,1,0] op_sel_hi:[1,0,1] neg_lo:[1,0,0]
    ds_read_b128 v[104:107], v226 offset:192
    v_pk_fma_f16 v153, v113, v117, v153 op_sel:[1,1,0] op_sel_hi:[1,0,1] neg_lo:[1,0,0]
    v_pk_fma_f16 v154, v114, v118, v154 op_sel:[1,1,0] op_sel_hi:[1,0,1] neg_lo:[1,0,0]
    v_pk_fma_f16 v155, v115, v119, v155 op_sel:[1,1,0] op_sel_hi:[1,0,1] neg_lo:[1,0,0]
    v_pk_fma_f16 v156, v120, v124, v156 op_sel:[1,1,0] op_sel_hi:[1,0,1] neg_lo:[1,0,0]
    ds_read_b128 v[108:111], v227 offset:192
    v_pk_fma_f16 v157, v121, v125, v157 op_sel:[1,1,0] op_sel_hi:[1,0,1] neg_lo:[1,0,0]
    v_pk_fma_f16 v158, v122, v126, v158 op_sel:[1,1,0] op_sel_hi:[1,0,1] neg_lo:[1,0,0]
    v_pk_fma_f16 v159, v123, v127, v159 op_sel:[1,1,0] op_sel_hi:[1,0,1] neg_lo:[1,0,0]
    s_waitcnt vmcnt(0)
    s_barrier
    s_cmp_lg_u32 s9, 0
    s_cbranch_scc1 A_nox
    v_readfirstlane_b32 s14, v3
    s_cmp_lg_u32 s14, 0
    s_cbranch_scc1 A_ep_ok
A_ep_retry:
    s_sub_u32 s98, s98, 1
    s_cbranch_scc1 L_exit
    s_sleep 1
    global_load_dword v3, v2, s[36:37] sc1
    s_waitcnt vmcnt(0)
    v_readfirstlane_b32 s14, v3
    s_cmp_eq_u32 s14, 0
    s_cbranch_scc1 A_ep_retry
A_ep_ok:
    s_lshl_b32 s12, 1, s6
    v_mov_b32 v244, s14
    v_mov_b32 v245, s58
    s_mov_b32 exec_lo, s12
    s_mov_b32 exec_hi, 0
    global_store_dwordx2 v242, v[244:245], s[38:39]
    s_mov_b64 exec, -1
A_nox:
    s_waitcnt lgkmcnt(8)
    v_pk_mul_f16 v160, v64, v68 op_sel:[0,0] op_sel_hi:[0,1]
    ds_read_b128 v[112:115], v224 offset:224
    v_pk_mul_f16 v161, v65, v69 op_sel:[0,0] op_sel_hi:[0,1]
    v_pk_mul_f16 v162, v66, v70 op_sel:[0,0] op_sel_hi:[0,1]
    v_pk_mul_f16 v163, v67, v71 op_sel:[0,0] op_sel_hi:[0,1]
    v_pk_mul_f16 v164, v72, v76 op_sel:[0,0] op_sel_hi:[0,1]
    ds_read_b128 v[116:119], v225 offset:224
    v_pk_mul_f16 v165, v73, v77 op_sel:[0,0] op_sel_hi:[0,1]
    v_mfma_f32_32x32x16_f16 v[32:47], v[156:159], v[152:155], v[32:47]
    v_pk_mul_f16 v166, v74, v78 op_sel:[0,0] op_sel_hi:[0,1]
    v_pk_mul_f16 v167, v75, v79 op_sel:[0,0] op_sel_hi:[0,1]
    v_pk_fma_f16 v160, v64, v68, v160 op_sel:[1,1,0] op_sel_hi:[1,0,1] neg_lo:[1,0,0]
    ds_read_b128 v[120:123], v226 offset:224
    v_pk_fma_f16 v161, v65, v69, v161 op_sel:[1,1,0] op_sel_hi:[1,0,1] neg_lo:[1,0,0]
    v_pk_fma_f16 v162, v66, v70, v162 op_sel:[1,1,0] op_sel_hi:[1,0,1] neg_lo:[1,0,0]
    v_pk_fma_f16 v163, v67, v71, v163 op_sel:[1,1,0] op_sel_hi:[1,0,1] neg_lo:[1,0,0]
    v_pk_fma_f16 v164, v72, v76, v164 op_sel:[1,1,0] op_sel_hi:[1,0,1] neg_lo:[1,0,0]
    ds_read_b128 v[124:127], v227 offset:224
    v_pk_fma_f16 v165, v73, v77, v165 op_sel:[1,1,0] op_sel_hi:[1,0,1] neg_lo:[1,0,0]
    v_pk_fma_f16 v166, v74, v78, v166 op_sel:[1,1,0] op_sel_hi:[1,0,1] neg_lo:[1,0,0]
    v_pk_fma_f16 v167, v75, v79, v167 op_sel:[1,1,0] op_sel_hi:[1,0,1] neg_lo:[1,0,0]
    s_waitcnt lgkmcnt(8)
    v_pk_mul_f16 v168, v80, v84 op_sel:[0,0] op_sel_hi:[0,1]
    ds_read_b128 v[64:67], v224 offset:256
    v_pk_mul_f16 v169, v81, v85 op_sel:[0,0] op_sel_hi:[0,1]
    v_pk_mul_f16 v170, v82, v86 op_sel:[0,0] op_sel_hi:[0,1]
    v_pk_mul_f16 v171, v83, v87 op_sel:[0,0] op_sel_hi:[0,1]
    v_pk_mul_f16 v172, v88, v92 op_sel:[0,0] op_sel_hi:[0,1]
    ds_read_b128 v[68:71], v225 offset:256
    v_pk_mul_f16 v173, v89, v93 op_sel:[0,0] op_sel_hi:[0,1]
    v_mfma_f32_32x32x16_f16 v[32:47], v[164:167], v[160:163], v[32:47]
    v_pk_mul_f16 v174, v90, v94 op_sel:[0,0] op_sel_hi:[0,1]
    v_pk_mul_f16 v175, v91, v95 op_sel:[0,0] op_sel_hi:[0,1]
    v_pk_fma_f16 v168, v80, v84, v168 op_sel:[1,1,0] op_sel_hi:[1,0,1] neg_lo:[1,0,0]
    ds_read_b128 v[72:75], v226 offset:256
    v_pk_fma_f16 v169, v81, v85, v169 op_sel:[1,1,0] op_sel_hi:[1,0,1] neg_lo:[1,0,0]
    v_pk_fma_f16 v170, v82, v86, v170 op_sel:[1,1,0] op_sel_hi:[1,0,1] neg_lo:[1,0,0]
    v_pk_fma_f16 v171, v83, v87, v171 op_sel:[1,1,0] op_sel_hi:[1,0,1] neg_lo:[1,0,0]
    v_pk_fma_f16 v172, v88, v92, v172 op_sel:[1,1,0] op_sel_hi:[1,0,1] neg_lo:[1,0,0]
    ds_read_b128 v[76:79], v227 offset:256
    v_pk_fma_f16 v173, v89, v93, v173 op_sel:[1,1,0] op_sel_hi:[1,0,1] neg_lo:[1,0,0]
    v_pk_fma_f16 v174, v90, v94, v174 op_sel:[1,1,0] op_sel_hi:[1,0,1] neg_lo:[1,0,0]
    v_pk_fma_f16 v175, v91, v95, v175 op_sel:[1,1,0] op_sel_hi:[1,0,1] neg_lo:[1,0,0]
    s_waitcnt lgkmcnt(8)
    v_pk_mul_f16 v176, v96, v100 op_sel:[0,0] op_sel_hi:[0,1]
    ds_read_b128 v[80:83], v224 offset:288
    v_pk_mul_f16 v177, v97, v101 op_sel:[0,0] op_sel_hi:[0,1]
    v_pk_mul_f16 v178, v98, v102 op_sel:[0,0] op_sel_hi:[0,1]
    v_pk_mul_f16 v179, v99, v103 op_sel:[0,0] op_sel_hi:[0,1]
    v_pk_mul_f16 v180, v104, v108 op_sel:[0,0] op_sel_hi:[0,1]
    ds_read_b128 v[84:87], v225 offset:288
    v_pk_mul_f16 v181, v105, v109 op_sel:[0,0] op_sel_hi:[0,1]
    v_mfma_f32_32x32x16_f16 v[32:47], v[172:175], v[168:171], v[32:47]
    v_pk_mul_f16 v182, v106, v110 op_sel:[0,0] op_sel_hi:[0,1]
    v_pk_mul_f16 v183, v107, v111 op_sel:[0,0] op_sel_hi:[0,1]
    v_pk_fma_f16 v176, v96, v100, v176 op_sel:[1,1,0] op_sel_hi:[1,0,1] neg_lo:[1,0,0]
    ds_read_b128 v[88:91], v226 offset:288
    v_pk_fma_f16 v177, v97, v101, v177 op_sel:[1,1,0] op_sel_hi:[1,0,1] neg_lo:[1,0,0]
    v_pk_fma_f16 v178, v98, v102, v178 op_sel:[1,1,0] op_sel_hi:[1,0,1] neg_lo:[1,0,0]
    v_pk_fma_f16 v179, v99, v103, v179 op_sel:[1,1,0] op_sel_hi:[1,0,1] neg_lo:[1,0,0]
    v_pk_fma_f16 v180, v104, v108, v180 op_sel:[1,1,0] op_sel_hi:[1,0,1] neg_lo:[1,0,0]
    ds_read_b128 v[92:95], v227 offset:288
    v_pk_fma_f16 v181, v105, v109, v181 op_sel:[1,1,0] op_sel_hi:[1,0,1] neg_lo:[1,0,0]
    v_pk_fma_f16 v182, v106, v110, v182 op_sel:[1,1,0] op_sel_hi:[1,0,1] neg_lo:[1,0,0]
    v_pk_fma_f16 v183, v107, v111, v183 op_sel:[1,1,0] op_sel_hi:[1,0,1] neg_lo:[1,0,0]
    s_waitcnt lgkmcnt(8)
    v_pk_mul_f16 v184, v112, v116 op_sel:[0,0] op_sel_hi:[0,1]
    ds_read_b128 v[96:99], v224 offset:320
    v_pk_mul_f16 v185, v113, v117 op_sel:[0,0] op_sel_hi:[0,1]
    v_pk_mul_f16 v186, v114, v118 op_sel:[0,0] op_sel_hi:[0,1]
    v_pk_mul_f16 v187, v115, v119 op_sel:[0,0] op_sel_hi:[0,1]
    v_pk_mul_f16 v188, v120, v124 op_sel:[0,0] op_sel_hi:[0,1]
    ds_read_b128 v[100:103], v225 offset:320
    v_pk_mul_f16 v189, v121, v125 op_sel:[0,0] op_sel_hi:[0,1]
    v_mfma_f32_32x32x16_f16 v[32:47], v[180:183], v[176:179], v[32:47]
    v_pk_mul_f16 v190, v122, v126 op_sel:[0,0] op_sel_hi:[0,1]
    v_pk_mul_f16 v191, v123, v127 op_sel:[0,0] op_sel_hi:[0,1]
    v_pk_fma_f16 v184, v112, v116, v184 op_sel:[1,1,0] op_sel_hi:[1,0,1] neg_lo:[1,0,0]
    ds_read_b128 v[104:107], v226 offset:320
    v_pk_fma_f16 v185, v113, v117, v185 op_sel:[1,1,0] op_sel_hi:[1,0,1] neg_lo:[1,0,0]
    v_pk_fma_f16 v186, v114, v118, v186 op_sel:[1,1,0] op_sel_hi:[1,0,1] neg_lo:[1,0,0]
    v_pk_fma_f16 v187, v115, v119, v187 op_sel:[1,1,0] op_sel_hi:[1,0,1] neg_lo:[1,0,0]
    v_pk_fma_f16 v188, v120, v124, v188 op_sel:[1,1,0] op_sel_hi:[1,0,1] neg_lo:[1,0,0]
    ds_read_b128 v[108:111], v227 offset:320
    v_pk_fma_f16 v189, v121, v125, v189 op_sel:[1,1,0] op_sel_hi:[1,0,1] neg_lo:[1,0,0]
    v_pk_fma_f16 v190, v122, v126, v190 op_sel:[1,1,0] op_sel_hi:[1,0,1] neg_lo:[1,0,0]
    v_pk_fma_f16 v191, v123, v127, v191 op_sel:[1,1,0] op_sel_hi:[1,0,1] neg_lo:[1,0,0]
    s_waitcnt lgkmcnt(8)
    v_pk_mul_f16 v128, v64, v68 op_sel:[0,0] op_sel_hi:[0,1]
    ds_read_b128 v[112:115], v224 offset:352
    v_pk_mul_f16 v129, v65, v69 op_sel:[0,0] op_sel_hi:[0,1]
    v_pk_mul_f16 v130, v66, v70 op_sel:[0,0] op_sel_hi:[0,1]
    v_pk_mul_f16 v131, v67, v71 op_sel:[0,0] op_sel_hi:[0,1]
    v_pk_mul_f16 v132, v72, v76 op_sel:[0,0] op_sel_hi:[0,1]
    ds_read_b128 v[116:119], v225 offset:352
    v_pk_mul_f16 v133, v73, v77 op_sel:[0,0] op_sel_hi:[0,1]
    v_mfma_f32_32x32x16_f16 v[32:47], v[188:191], v[184:187], v[32:47]
    v_pk_mul_f16 v134, v74, v78 op_sel:[0,0] op_sel_hi:[0,1]
    v_pk_mul_f16 v135, v75, v79 op_sel:[0,0] op_sel_hi:[0,1]
    v_pk_fma_f16 v128, v64, v68, v128 op_sel:[1,1,0] op_sel_hi:[1,0,1] neg_lo:[1,0,0]
    ds_read_b128 v[120:123], v226 offset:352
    v_pk_fma_f16 v129, v65, v69, v129 op_sel:[1,1,0] op_sel_hi:[1,0,1] neg_lo:[1,0,0]
    v_pk_fma_f16 v130, v66, v70, v130 op_sel:[1,1,0] op_sel_hi:[1,0,1] neg_lo:[1,0,0]
    v_pk_fma_f16 v131, v67, v71, v131 op_sel:[1,1,0] op_sel_hi:[1,0,1] neg_lo:[1,0,0]
    v_pk_fma_f16 v132, v72, v76, v132 op_sel:[1,1,0] op_sel_hi:[1,0,1] neg_lo:[1,0,0]
    ds_read_b128 v[124:127], v227 offset:352
    v_pk_fma_f16 v133, v73, v77, v133 op_sel:[1,1,0] op_sel_hi:[1,0,1] neg_lo:[1,0,0]
    v_pk_fma_f16 v134, v74, v78, v134 op_sel:[1,1,0] op_sel_hi:[1,0,1] neg_lo:[1,0,0]
    v_pk_fma_f16 v135, v75, v79, v135 op_sel:[1,1,0] op_sel_hi:[1,0,1] neg_lo:[1,0,0]
    s_waitcnt lgkmcnt(8)
    v_pk_mul_f16 v136, v80, v84 op_sel:[0,0] op_sel_hi:[0,1]
    ds_read_b128 v[64:67], v224 offset:384
    v_pk_mul_f16 v137, v81, v85 op_sel:[0,0] op_sel_hi:[0,1]
    v_pk_mul_f16 v138, v82, v86 op_sel:[0,0] op_sel_hi:[0,1]
    v_pk_mul_f16 v139, v83, v87 op_sel:[0,0] op_sel_hi:[0,1]
    v_pk_mul_f16 v140, v88, v92 op_sel:[0,0] op_sel_hi:[0,1]
    ds_read_b128 v[68:71], v225 offset:384
    v_pk_mul_f16 v141, v89, v93 op_sel:[0,0] op_sel_hi:[0,1]
    v_mfma_f32_32x32x16_f16 v[32:47], v[132:135], v[128:131], v[32:47]
    v_pk_mul_f16 v142, v90, v94 op_sel:[0,0] op_sel_hi:[0,1]
    v_pk_mul_f16 v143, v91, v95 op_sel:[0,0] op_sel_hi:[0,1]
    v_pk_fma_f16 v136, v80, v84, v136 op_sel:[1,1,0] op_sel_hi:[1,0,1] neg_lo:[1,0,0]
    ds_read_b128 v[72:75], v226 offset:384
    v_pk_fma_f16 v137, v81, v85, v137 op_sel:[1,1,0] op_sel_hi:[1,0,1] neg_lo:[1,0,0]
    v_pk_fma_f16 v138, v82, v86, v138 op_sel:[1,1,0] op_sel_hi:[1,0,1] neg_lo:[1,0,0]
    v_pk_fma_f16 v139, v83, v87, v139 op_sel:[1,1,0] op_sel_hi:[1,0,1] neg_lo:[1,0,0]
    v_pk_fma_f16 v140, v88, v92, v140 op_sel:[1,1,0] op_sel_hi:[1,0,1] neg_lo:[1,0,0]
    ds_read_b128 v[76:79], v227 offset:384
    v_pk_fma_f16 v141, v89, v93, v141 op_sel:[1,1,0] op_sel_hi:[1,0,1] neg_lo:[1,0,0]
    v_pk_fma_f16 v142, v90, v94, v142 op_sel:[1,1,0] op_sel_hi:[1,0,1] neg_lo:[1,0,0]
    v_pk_fma_f16 v143, v91, v95, v143 op_sel:[1,1,0] op_sel_hi:[1,0,1] neg_lo:[1,0,0]
    s_lshl_b32 s12, s11, 17
    s_lshl_b32 s13, s10, 4
    s_add_u32 s12, s12, s13
    s_lshl_b32 s13, s6, 6
    s_add_u32 s62, s12, s13
    s_add_u32 s13, s62, 65536
    s_mov_b32 m0, s68
    v_mov_b32 v7, 70912
    s_cmp_lg_u32 s9, 0
    s_cbranch_scc1 A_u_b
    s_mov_b32 s59, 60
A_u_p:
    s_sub_u32 s59, s59, 1
    s_cbranch_scc1 A_u_t
    global_load_dwordx2 v[244:245], v242, s[38:39] sc1
A_u_p1:
    s_waitcnt vmcnt(0)
    v_cmp_ne_u32 vcc, s14, v244
    v_cmp_ne_u32 s[92:93], s58, v245
    s_or_b64 vcc, vcc, s[92:93]
    s_and_b64 exec, exec, vcc
    s_cbranch_execnz A_u_p
    s_mov_b32 s59, 0
A_u_t:
    s_mov_b64 exec, -1
    s_add_u32 s59, s59, 1
    v_mov_b32 v240, s59
    ds_write_b32 v7, v240
A_u_b:
    s_waitcnt lgkmcnt(0)
    s_barrier
    ds_read_b32 v240, v7
    s_waitcnt lgkmcnt(0)
    v_readfirstlane_b32 s59, v240
    s_cmp_lg_u32 s59, 0
    s_cbranch_scc1 A_u_ok
    buffer_store_dwordx4 v[232:235], v246, s[40:43], s69 offen sc1
    buffer_store_dwordx4 v[236:239], v246, s[40:43], s69 offen offset:1024 sc1
    s_waitcnt vmcnt(0)
    s_barrier
    s_cmp_lg_u32 s9, 0
    s_cbranch_scc1 A_u_c
    v_add_u32 v241, 32768, v242
    s_lshl_b32 s92, 1, s6
    v_mov_b32 v240, s14
    s_mov_b32 exec_lo, s92
    s_mov_b32 exec_hi, 0
    global_store_dword v241, v240, s[38:39] sc1
    s_mov_b64 exec, -1
A_u_q:
    s_sub_u32 s98, s98, 1
    s_cbranch_scc1 L_exit
    global_load_dwordx2 v[244:245], v242, s[38:39] sc1
    global_load_dword v240, v241, s[38:39] sc1
    s_waitcnt vmcnt(0)
    v_cmp_eq_u32 vcc, s14, v240
    s_cmp_eq_u64 vcc, -1
    s_cbranch_scc1 A_u_d
    v_cmp_eq_u32 vcc, s14, v244
    v_cmp_eq_u32 s[92:93], s58, v245
    s_and_b64 vcc, vcc, s[92:93]
    s_cmp_eq_u64 vcc, -1
    s_cbranch_scc0 A_u_q
    s_mov_b32 s59, 1
A_u_d:
    v_mov_b32 v240, s59
    ds_write_b32 v7, v240
A_u_c:
    s_waitcnt lgkmcnt(0)
    s_barrier
    ds_read_b32 v240, v7
    s_waitcnt lgkmcnt(0)
    v_readfirstlane_b32 s59, v240
A_u_ok:
    buffer_load_dwordx4 v22, s[40:43], s62 offen sc1 lds
    s_add_u32 m0, m0, 1024
    s_nop 0
    buffer_load_dwordx4 v22, s[40:43], s13 offen sc1 lds
    s_waitcnt lgkmcnt(8)
    v_pk_mul_f16 v144, v96, v100 op_sel:[0,0] op_sel_hi:[0,1]
    ds_read_b128 v[80:83], v224 offset:416
    v_pk_mul_f16 v145, v97, v101 op_sel:[0,0] op_sel_hi:[0,1]
    v_pk_mul_f16 v146, v98, v102 op_sel:[0,0] op_sel_hi:[0,1]
    v_pk_mul_f16 v147, v99, v103 op_sel:[0,0] op_sel_hi:[0,1]
    v_pk_mul_f16 v148, v104, v108 op_sel:[0,0] op_sel_hi:[0,1]
    ds_read_b128 v[84:87], v225 offset:416
    v_pk_mul_f16 v149, v105, v109 op_sel:[0,0] op_sel_hi:[0,1]
    v_mfma_f32_32x32x16_f16 v[32:47], v[140:143], v[136:139], v[32:47]
    v_pk_mul_f16 v150, v106, v110 op_sel:[0,0] op_sel_hi:[0,1]
    v_pk_mul_f16 v151, v107, v111 op_sel:[0,0] op_sel_hi:[0,1]
    v_pk_fma_f16 v144, v96, v100, v144 op_sel:[1,1,0] op_sel_hi:[1,0,1] neg_lo:[1,0,0]
    ds_read_b128 v[88:91], v226 offset:416
    v_pk_fma_f16 v145, v97, v101, v145 op_sel:[1,1,0] op_sel_hi:[1,0,1] neg_lo:[1,0,0]
    v_pk_fma_f16 v146, v98, v102, v146 op_sel:[1,1,0] op_sel_hi:[1,0,1] neg_lo:[1,0,0]
    v_pk_fma_f16 v147, v99, v103, v147 op_sel:[1,1,0] op_sel_hi:[1,0,1] neg_lo:[1,0,0]
    v_pk_fma_f16 v148, v104, v108, v148 op_sel:[1,1,0] op_sel_hi:[1,0,1] neg_lo:[1,0,0]
    ds_read_b128 v[92:95], v227 offset:416
    v_pk_fma_f16 v149, v105, v109, v149 op_sel:[1,1,0] op_sel_hi:[1,0,1] neg_lo:[1,0,0]
    v_pk_fma_f16 v150, v106, v110, v150 op_sel:[1,1,0] op_sel_hi:[1,0,1] neg_lo:[1,0,0]
    v_pk_fma_f16 v151, v107, v111, v151 op_sel:[1,1,0] op_sel_hi:[1,0,1] neg_lo:[1,0,0]
    s_waitcnt lgkmcnt(8)
    v_pk_mul_f16 v152, v112, v116 op_sel:[0,0] op_sel_hi:[0,1]
    ds_read_b128 v[96:99], v224 offset:448
    v_pk_mul_f16 v153, v113, v117 op_sel:[0,0] op_sel_hi:[0,1]
    v_pk_mul_f16 v154, v114, v118 op_sel:[0,0] op_sel_hi:[0,1]
    v_pk_mul_f16 v155, v115, v119 op_sel:[0,0] op_sel_hi:[0,1]
    v_pk_mul_f16 v156, v120, v124 op_sel:[0,0] op_sel_hi:[0,1]
    ds_read_b128 v[100:103], v225 offset:448
    v_pk_mul_f16 v157, v121, v125 op_sel:[0,0] op_sel_hi:[0,1]
    v_mfma_f32_32x32x16_f16 v[32:47], v[148:151], v[144:147], v[32:47]
    v_pk_mul_f16 v158, v122, v126 op_sel:[0,0] op_sel_hi:[0,1]
    v_pk_mul_f16 v159, v123, v127 op_sel:[0,0] op_sel_hi:[0,1]
    v_pk_fma_f16 v152, v112, v116, v152 op_sel:[1,1,0] op_sel_hi:[1,0,1] neg_lo:[1,0,0]
    ds_read_b128 v[104:107], v226 offset:448
    v_pk_fma_f16 v153, v113, v117, v153 op_sel:[1,1,0] op_sel_hi:[1,0,1] neg_lo:[1,0,0]
    v_pk_fma_f16 v154, v114, v118, v154 op_sel:[1,1,0] op_sel_hi:[1,0,1] neg_lo:[1,0,0]
    v_pk_fma_f16 v155, v115, v119, v155 op_sel:[1,1,0] op_sel_hi:[1,0,1] neg_lo:[1,0,0]
    v_pk_fma_f16 v156, v120, v124, v156 op_sel:[1,1,0] op_sel_hi:[1,0,1] neg_lo:[1,0,0]
    ds_read_b128 v[108:111], v227 offset:448
    v_pk_fma_f16 v157, v121, v125, v157 op_sel:[1,1,0] op_sel_hi:[1,0,1] neg_lo:[1,0,0]
    v_pk_fma_f16 v158, v122, v126, v158 op_sel:[1,1,0] op_sel_hi:[1,0,1] neg_lo:[1,0,0]
    v_pk_fma_f16 v159, v123, v127, v159 op_sel:[1,1,0] op_sel_hi:[1,0,1] neg_lo:[1,0,0]
    s_waitcnt lgkmcnt(8)
    v_pk_mul_f16 v160, v64, v68 op_sel:[0,0] op_sel_hi:[0,1]
    ds_read_b128 v[112:115], v224 offset:480
    v_pk_mul_f16 v161, v65, v69 op_sel:[0,0] op_sel_hi:[0,1]
    v_pk_mul_f16 v162, v66, v70 op_sel:[0,0] op_sel_hi:[0,1]
    v_pk_mul_f16 v163, v67, v71 op_sel:[0,0] op_sel_hi:[0,1]
    v_pk_mul_f16 v164, v72, v76 op_sel:[0,0] op_sel_hi:[0,1]
    ds_read_b128 v[116:119], v225 offset:480
    v_pk_mul_f16 v165, v73, v77 op_sel:[0,0] op_sel_hi:[0,1]
    v_mfma_f32_32x32x16_f16 v[32:47], v[156:159], v[152:155], v[32:47]
    v_pk_mul_f16 v166, v74, v78 op_sel:[0,0] op_sel_hi:[0,1]
    v_pk_mul_f16 v167, v75, v79 op_sel:[0,0] op_sel_hi:[0,1]
    v_pk_fma_f16 v160, v64, v68, v160 op_sel:[1,1,0] op_sel_hi:[1,0,1] neg_lo:[1,0,0]
    ds_read_b128 v[120:123], v226 offset:480
    v_pk_fma_f16 v161, v65, v69, v161 op_sel:[1,1,0] op_sel_hi:[1,0,1] neg_lo:[1,0,0]
    v_pk_fma_f16 v162, v66, v70, v162 op_sel:[1,1,0] op_sel_hi:[1,0,1] neg_lo:[1,0,0]
    v_pk_fma_f16 v163, v67, v71, v163 op_sel:[1,1,0] op_sel_hi:[1,0,1] neg_lo:[1,0,0]
    v_pk_fma_f16 v164, v72, v76, v164 op_sel:[1,1,0] op_sel_hi:[1,0,1] neg_lo:[1,0,0]
    ds_read_b128 v[124:127], v227 offset:480
    v_pk_fma_f16 v165, v73, v77, v165 op_sel:[1,1,0] op_sel_hi:[1,0,1] neg_lo:[1,0,0]
    v_pk_fma_f16 v166, v74, v78, v166 op_sel:[1,1,0] op_sel_hi:[1,0,1] neg_lo:[1,0,0]
    v_pk_fma_f16 v167, v75, v79, v167 op_sel:[1,1,0] op_sel_hi:[1,0,1] neg_lo:[1,0,0]
    s_waitcnt lgkmcnt(8)
    v_pk_mul_f16 v168, v80, v84 op_sel:[0,0] op_sel_hi:[0,1]
    v_pk_mul_f16 v169, v81, v85 op_sel:[0,0] op_sel_hi:[0,1]
    v_pk_mul_f16 v170, v82, v86 op_sel:[0,0] op_sel_hi:[0,1]
    v_pk_mul_f16 v171, v83, v87 op_sel:[0,0] op_sel_hi:[0,1]
    v_pk_mul_f16 v172, v88, v92 op_sel:[0,0] op_sel_hi:[0,1]
    v_pk_mul_f16 v173, v89, v93 op_sel:[0,0] op_sel_hi:[0,1]
    v_mfma_f32_32x32x16_f16 v[32:47], v[164:167], v[160:163], v[32:47]
    v_pk_mul_f16 v174, v90, v94 op_sel:[0,0] op_sel_hi:[0,1]
    v_pk_mul_f16 v175, v91, v95 op_sel:[0,0] op_sel_hi:[0,1]
    v_pk_fma_f16 v168, v80, v84, v168 op_sel:[1,1,0] op_sel_hi:[1,0,1] neg_lo:[1,0,0]
    v_pk_fma_f16 v169, v81, v85, v169 op_sel:[1,1,0] op_sel_hi:[1,0,1] neg_lo:[1,0,0]
    v_pk_fma_f16 v170, v82, v86, v170 op_sel:[1,1,0] op_sel_hi:[1,0,1] neg_lo:[1,0,0]
    v_pk_fma_f16 v171, v83, v87, v171 op_sel:[1,1,0] op_sel_hi:[1,0,1] neg_lo:[1,0,0]
    v_pk_fma_f16 v172, v88, v92, v172 op_sel:[1,1,0] op_sel_hi:[1,0,1] neg_lo:[1,0,0]
    v_pk_fma_f16 v173, v89, v93, v173 op_sel:[1,1,0] op_sel_hi:[1,0,1] neg_lo:[1,0,0]
    v_pk_fma_f16 v174, v90, v94, v174 op_sel:[1,1,0] op_sel_hi:[1,0,1] neg_lo:[1,0,0]
    v_pk_fma_f16 v175, v91, v95, v175 op_sel:[1,1,0] op_sel_hi:[1,0,1] neg_lo:[1,0,0]
    s_waitcnt lgkmcnt(4)
    v_pk_mul_f16 v176, v96, v100 op_sel:[0,0] op_sel_hi:[0,1]
    v_pk_mul_f16 v177, v97, v101 op_sel:[0,0] op_sel_hi:[0,1]
    v_pk_mul_f16 v178, v98, v102 op_sel:[0,0] op_sel_hi:[0,1]
    v_pk_mul_f16 v179, v99, v103 op_sel:[0,0] op_sel_hi:[0,1]
    v_pk_mul_f16 v180, v104, v108 op_sel:[0,0] op_sel_hi:[0,1]
    v_pk_mul_f16 v181, v105, v109 op_sel:[0,0] op_sel_hi:[0,1]
    v_mfma_f32_32x32x16_f16 v[32:47], v[172:175], v[168:171], v[32:47]
    v_pk_mul_f16 v182, v106, v110 op_sel:[0,0] op_sel_hi:[0,1]
    v_pk_mul_f16 v183, v107, v111 op_sel:[0,0] op_sel_hi:[0,1]
    v_pk_fma_f16 v176, v96, v100, v176 op_sel:[1,1,0] op_sel_hi:[1,0,1] neg_lo:[1,0,0]
    v_pk_fma_f16 v177, v97, v101, v177 op_sel:[1,1,0] op_sel_hi:[1,0,1] neg_lo:[1,0,0]
    v_pk_fma_f16 v178, v98, v102, v178 op_sel:[1,1,0] op_sel_hi:[1,0,1] neg_lo:[1,0,0]
    v_pk_fma_f16 v179, v99, v103, v179 op_sel:[1,1,0] op_sel_hi:[1,0,1] neg_lo:[1,0,0]
    v_pk_fma_f16 v180, v104, v108, v180 op_sel:[1,1,0] op_sel_hi:[1,0,1] neg_lo:[1,0,0]
    v_pk_fma_f16 v181, v105, v109, v181 op_sel:[1,1,0] op_sel_hi:[1,0,1] neg_lo:[1,0,0]
    v_pk_fma_f16 v182, v106, v110, v182 op_sel:[1,1,0] op_sel_hi:[1,0,1] neg_lo:[1,0,0]
    v_pk_fma_f16 v183, v107, v111, v183 op_sel:[1,1,0] op_sel_hi:[1,0,1] neg_lo:[1,0,0]
    s_waitcnt lgkmcnt(0)
    v_pk_mul_f16 v184, v112, v116 op_sel:[0,0] op_sel_hi:[0,1]
    v_pk_mul_f16 v185, v113, v117 op_sel:[0,0] op_sel_hi:[0,1]
    v_pk_mul_f16 v186, v114, v118 op_sel:[0,0] op_sel_hi:[0,1]
    v_pk_mul_f16 v187, v115, v119 op_sel:[0,0] op_sel_hi:[0,1]
    v_pk_mul_f16 v188, v120, v124 op_sel:[0,0] op_sel_hi:[0,1]
    v_pk_mul_f16 v189, v121, v125 op_sel:[0,0] op_sel_hi:[0,1]
    v_mfma_f32_32x32x16_f16 v[32:47], v[180:183], v[176:179], v[32:47]
    v_pk_mul_f16 v190, v122, v126 op_sel:[0,0] op_sel_hi:[0,1]
    v_pk_mul_f16 v191, v123, v127 op_sel:[0,0] op_sel_hi:[0,1]
    v_pk_fma_f16 v184, v112, v116, v184 op_sel:[1,1,0] op_sel_hi:[1,0,1] neg_lo:[1,0,0]
    v_pk_fma_f16 v185, v113, v117, v185 op_sel:[1,1,0] op_sel_hi:[1,0,1] neg_lo:[1,0,0]
    v_pk_fma_f16 v186, v114, v118, v186 op_sel:[1,1,0] op_sel_hi:[1,0,1] neg_lo:[1,0,0]
    v_pk_fma_f16 v187, v115, v119, v187 op_sel:[1,1,0] op_sel_hi:[1,0,1] neg_lo:[1,0,0]
    v_pk_fma_f16 v188, v120, v124, v188 op_sel:[1,1,0] op_sel_hi:[1,0,1] neg_lo:[1,0,0]
    v_pk_fma_f16 v189, v121, v125, v189 op_sel:[1,1,0] op_sel_hi:[1,0,1] neg_lo:[1,0,0]
    v_pk_fma_f16 v190, v122, v126, v190 op_sel:[1,1,0] op_sel_hi:[1,0,1] neg_lo:[1,0,0]
    v_pk_fma_f16 v191, v123, v127, v191 op_sel:[1,1,0] op_sel_hi:[1,0,1] neg_lo:[1,0,0]
    s_nop 1
    v_mfma_f32_32x32x16_f16 v[32:47], v[188:191], v[184:187], v[32:47]
    s_setprio 2
    s_mul_i32 s12, s9, 14336
    v_add_u32 v24, s12, v23
    s_xor_b32 s13, s9, 1
    s_mul_i32 s13, s13, 14336
    v_add_u32 v25, s13, v23
    s_nop 5
    v_mul_f32 v32, v19, v32
    v_mul_f32 v33, v19, v33
    v_mul_f32 v34, v19, v34
    v_mul_f32 v35, v19, v35
    v_mul_f32 v36, v19, v36
    v_mul_f32 v37, v19, v37
    v_mul_f32 v38, v19, v38
    v_mul_f32 v39, v19, v39
    v_mul_f32 v40, v19, v40
    v_mul_f32 v41, v19, v41
    v_mul_f32 v42, v19, v42
    s_cmp_lg_u32 s11, 0
    s_cbranch_scc1 A_w1
    ds_write_b128 v24, v[38:41]
    ds_write_b128 v24, v[42:45] offset:1024
    s_branch A_w2
A_w1:
    ds_write_b128 v24, v[32:35]
    ds_write_b64 v24, v[36:37] offset:1024
A_w2:
    s_mul_i32 s12, s10, 1408
    s_add_u32 s12, s12, 68096
    s_lshl_b32 s13, s11, 1
    s_sub_u32 s56, 4, s13
    s_lshl_b32 s57, s11, 2
    s_add_u32 s57, s57, 3
    v_lshlrev_b32 v26, s56, v31
    v_lshlrev_b32 v27, s57, v30
    v_add3_u32 v26, v26, v27, s12
    s_sub_u32 s56, s56, 1
    s_mul_i32 s57, s11, 5
    s_add_u32 s57, s57, 2
    v_lshlrev_b32 v27, s56, v31
    v_lshlrev_b32 v28, s57, v30
    v_add3_u32 v27, v27, v28, s12
    s_waitcnt lgkmcnt(0)
    s_barrier
    ds_read_b128 v[64:67], v25
    ds_read_b64 v[68:69], v25 offset:1024
    s_cmp_lg_u32 s11, 0
    s_cbranch_scc1 A_x1
    s_mov_b64 exec, 1
    v_add_f32 v32, s53, v32
    s_mov_b64 exec, -1
    s_waitcnt lgkmcnt(0)
    v_add_f32 v32, v32, v64
    v_add_f32 v33, v33, v65
    v_add_f32 v34, v34, v66
    v_add_f32 v35, v35, v67
    v_add_f32 v36, v36, v68
    v_add_f32 v37, v37, v69
    v_cvt_pk_bf16_f32 v64, v32, v33
    v_cvt_pk_bf16_f32 v66, v34, v35
    v_cvt_pk_bf16_f32 v68, v36, v37
    ds_write_b16 v26, v64
    ds_write_b16_d16_hi v26, v64 offset:2
    ds_write_b16 v26, v66 offset:4
    ds_write_b16_d16_hi v26, v66 offset:6
    ds_write_b16 v27, v68 offset:512
    ds_write_b16_d16_hi v27, v68 offset:514
    s_branch A_x2
A_x1:
    s_waitcnt lgkmcnt(0)
    v_add_f32 v38, v38, v64
    v_add_f32 v39, v39, v65
    v_add_f32 v40, v40, v66
    v_add_f32 v41, v41, v67
    v_add_f32 v42, v42, v68
    v_add_f32 v43, v43, v69
    v_cvt_pk_bf16_f32 v64, v38, v39
    v_cvt_pk_bf16_f32 v66, v40, v41
    v_cvt_pk_bf16_f32 v68, v42, v43
    ds_write_b16 v26, v64 offset:768
    ds_write_b16_d16_hi v26, v64 offset:770
    ds_write_b16 v27, v66 offset:1024
    ds_write_b16_d16_hi v27, v66 offset:1088
    s_mov_b64 exec, 0xffffffff
    ds_write_b16 v27, v68 offset:1280
    s_mov_b64 exec, -1
A_x2:
    v_lshlrev_b32 v24, 4, v29
    v_lshrrev_b32 v25, 4, v1
    v_mul_u32_u24 v26, 16640, v25
    v_bfe_u32 v27, v1, 2, 2
    v_mul_u32_u24 v28, 4160, v27
    v_add_u32 v26, v26, v28
    v_and_b32 v28, 3, v1
    v_lshl_add_u32 v26, v28, 4, v26
    v_sub_u32 v28, 3, v28
    v_mul_u32_u24 v28, 4160, v28
    v_lshlrev_b32 v27, 3, v27
    v_sub_u32 v28, v28, v27
    v_lshl_add_u32 v28, v25, 4, v28
    s_mul_i32 s12, s10, 16640
    s_lshl_b32 s13, s11, 8
    s_sub_u32 s12, s12, s13
    s_add_u32 s12, s12, 728
    v_add_u32 v4, s12, v28
    v_and_b32 v27, 15, v1
    v_lshlrev_b32 v28, 5, v27
    v_lshl_add_u32 v28, v25, 4, v28
    s_mul_i32 s12, s10, 4608
    s_sub_u32 s12, s12, s13
    s_add_u32 s12, s12, 59360
    v_add_u32 v5, s12, v28
    v_mov_b32 v132, 0
    v_mov_b32 v133, 0
    v_mov_b32 v134, 0
    v_mov_b32 v135, 0
    s_waitcnt lgkmcnt(0)
    s_barrier
    ds_read_u16 v64, v8 offset:0
    ds_read_u16 v65, v9 offset:0
    ds_read_u16 v66, v10 offset:0
    ds_read_u16 v67, v11 offset:0
    ds_read_u16 v68, v12 offset:0
    ds_read_u16 v69, v13 offset:0
    ds_read_u16 v70, v14 offset:0
    ds_read_u16 v71, v15 offset:0
    ds_read_u16 v72, v16 offset:0
    ds_read_u16 v73, v17 offset:0
    ds_read_u16 v74, v18 offset:0
    ds_read_u16 v80, v8 offset:1408
    ds_read_u16 v81, v9 offset:1408
    ds_read_u16 v82, v10 offset:1408
    ds_read_u16 v83, v11 offset:1408
    s_waitcnt lgkmcnt(4)
    ds_read_u16 v84, v12 offset:1408
    ds_read_u16 v85, v13 offset:1408
    ds_read_u16 v86, v14 offset:1408
    ds_read_u16 v87, v15 offset:1408
    ds_read_u16 v88, v16 offset:1408
    ds_read_u16 v89, v17 offset:1408
    ds_read_u16 v90, v18 offset:1408
    v_lshl_or_b32 v100, v65, 16, v64
    v_lshl_or_b32 v101, v67, 16, v66
    v_lshl_or_b32 v102, v69, 16, v68
    v_lshl_or_b32 v103, v71, 16, v70
    ds_write_b128 v24, v[100:103] offset:256
    v_lshl_or_b32 v104, v66, 16, v65
    v_lshl_or_b32 v105, v68, 16, v67
    v_lshl_or_b32 v106, v70, 16, v69
    v_lshl_or_b32 v107, v72, 16, v71
    ds_write_b128 v24, v[104:107] offset:4416
    v_lshl_or_b32 v108, v67, 16, v66
    v_lshl_or_b32 v109, v69, 16, v68
    v_lshl_or_b32 v110, v71, 16, v70
    v_lshl_or_b32 v111, v73, 16, v72
    ds_write_b128 v24, v[108:111] offset:8576
    v_lshl_or_b32 v112, v68, 16, v67
    v_lshl_or_b32 v113, v70, 16, v69
    v_lshl_or_b32 v114, v72, 16, v71
    v_lshl_or_b32 v115, v74, 16, v73
    ds_write_b128 v24, v[112:115] offset:12736
    s_waitcnt lgkmcnt(4)
    v_lshl_or_b32 v116, v81, 16, v80
    v_lshl_or_b32 v117, v83, 16, v82
    v_lshl_or_b32 v118, v85, 16, v84
    v_lshl_or_b32 v119, v87, 16, v86
    ds_write_b128 v24, v[116:119] offset:16896
    v_lshl_or_b32 v120, v82, 16, v81
    v_lshl_or_b32 v121, v84, 16, v83
    v_lshl_or_b32 v122, v86, 16, v85
    v_lshl_or_b32 v123, v88, 16, v87
    ds_write_b128 v24, v[120:123] offset:21056
    v_lshl_or_b32 v124, v83, 16, v82
    v_lshl_or_b32 v125, v85, 16, v84
    v_lshl_or_b32 v126, v87, 16, v86
    v_lshl_or_b32 v127, v89, 16, v88
    ds_write_b128 v24, v[124:127] offset:25216
    v_lshl_or_b32 v128, v84, 16, v83
    v_lshl_or_b32 v129, v86, 16, v85
    v_lshl_or_b32 v130, v88, 16, v87
    v_lshl_or_b32 v131, v90, 16, v89
    ds_write_b128 v24, v[128:131] offset:29376
    s_mov_b64 exec, 0xffffffff
    ds_write_b128 v26, v[132:135] offset:4352
    s_mov_b64 exec, -1
    v_mov_b32 v32, 0
    v_mov_b32 v33, 0
    v_mov_b32 v34, 0
    v_mov_b32 v35, 0
    v_mov_b32 v36, 0
    v_mov_b32 v37, 0
    v_mov_b32 v38, 0
    v_mov_b32 v39, 0
    v_mov_b32 v40, 0
    v_mov_b32 v41, 0
    v_mov_b32 v42, 0
    v_mov_b32 v43, 0
    v_mov_b32 v44, 0
    v_mov_b32 v45, 0
    v_mov_b32 v46, 0
    v_mov_b32 v47, 0
    v_mov_b32 v48, 0
    v_mov_b32 v49, 0
    v_mov_b32 v50, 0
    v_mov_b32 v51, 0
    v_mov_b32 v52, 0
    v_mov_b32 v53, 0
    v_mov_b32 v54, 0
    v_mov_b32 v55, 0
    v_mov_b32 v56, 0
    v_mov_b32 v57, 0
    v_mov_b32 v58, 0
    v_mov_b32 v59, 0
    v_mov_b32 v60, 0
    v_mov_b32 v61, 0
    v_mov_b32 v62, 0
    v_mov_b32 v63, 0
    s_waitcnt vmcnt(0) lgkmcnt(0)
    s_barrier
    ds_read_b64 v[64:65], v4 offset:3584
    ds_read_b64 v[66:67], v4 offset:3592
    ds_read_b128 v[96:99], v5 offset:0
    ds_read_b64 v[68:69], v4 offset:3072
    ds_read_b64 v[70:71], v4 offset:3080
    ds_read_b128 v[100:103], v5 offset:512
    ds_read_b64 v[72:73], v4 offset:2560
    ds_read_b64 v[74:75], v4 offset:2568
    ds_read_b128 v[104:107], v5 offset:1024
    ds_read_b64 v[76:77], v4 offset:2048
    ds_read_b64 v[78:79], v4 offset:2056
    ds_read_b128 v[108:111], v5 offset:1536
    ds_read_b64 v[80:81], v4 offset:1536
    ds_read_b64 v[82:83], v4 offset:1544
    ds_read_b128 v[112:115], v5 offset:2048
    ds_read_b64 v[84:85], v4 offset:1024
    ds_read_b64 v[86:87], v4 offset:1032
    ds_read_b128 v[116:119], v5 offset:2560
    ds_read_b64 v[88:89], v4 offset:512
    ds_read_b64 v[90:91], v4 offset:520
    ds_read_b128 v[120:123], v5 offset:3072
    ds_read_b64 v[92:93], v4 offset:0
    ds_read_b64 v[94:95], v4 offset:8
    ds_read_b128 v[124:127], v5 offset:3584
    v_subrev_u32 v4, 64, v4
    v_subrev_u32 v5, 64, v5
    s_mov_b32 s15, 2
A_conv:
    s_waitcnt lgkmcnt(0)
    v_mfma_f32_16x16x32_bf16 v[32:35], v[64:67], v[96:99], v[32:35]
    ds_read_b64 v[128:129], v4 offset:3584
    v_mfma_f32_16x16x32_bf16 v[36:39], v[64:67], v[100:103], v[36:39]
    ds_read_b64 v[130:131], v4 offset:3592
    v_mfma_f32_16x16x32_bf16 v[36:39], v[68:71], v[96:99], v[36:39]
    ds_read_b128 v[160:163], v5 offset:0
    v_mfma_f32_16x16x32_bf16 v[40:43], v[68:71], v[100:103], v[40:43]
    ds_read_b64 v[132:133], v4 offset:3072
    v_mfma_f32_16x16x32_bf16 v[40:43], v[64:67], v[104:107], v[40:43]
    ds_read_b64 v[134:135], v4 offset:3080
    v_mfma_f32_16x16x32_bf16 v[44:47], v[68:71], v[104:107], v[44:47]
    ds_read_b128 v[164:167], v5 offset:512
    v_mfma_f32_16x16x32_bf16 v[40:43], v[72:75], v[96:99], v[40:43]
    ds_read_b64 v[136:137], v4 offset:2560
    v_mfma_f32_16x16x32_bf16 v[44:47], v[72:75], v[100:103], v[44:47]
    ds_read_b64 v[138:139], v4 offset:2568
    v_mfma_f32_16x16x32_bf16 v[48:51], v[72:75], v[104:107], v[48:51]
    ds_read_b128 v[168:171], v5 offset:1024
    v_mfma_f32_16x16x32_bf16 v[44:47], v[64:67], v[108:111], v[44:47]
    ds_read_b64 v[140:141], v4 offset:2048
    v_mfma_f32_16x16x32_bf16 v[48:51], v[68:71], v[108:111], v[48:51]
    ds_read_b64 v[142:143], v4 offset:2056
    v_mfma_f32_16x16x32_bf16 v[52:55], v[72:75], v[108:111], v[52:55]
    ds_read_b128 v[172:175], v5 offset:1536
    v_mfma_f32_16x16x32_bf16 v[44:47], v[76:79], v[96:99], v[44:47]
    ds_read_b64 v[144:145], v4 offset:1536
    v_mfma_f32_16x16x32_bf16 v[48:51], v[76:79], v[100:103], v[48:51]
    ds_read_b64 v[146:147], v4 offset:1544
    v_mfma_f32_16x16x32_bf16 v[52:55], v[76:79], v[104:107], v[52:55]
    ds_read_b128 v[176:179], v5 offset:2048
    v_mfma_f32_16x16x32_bf16 v[56:59], v[76:79], v[108:111], v[56:59]
    ds_read_b64 v[148:149], v4 offset:1024
    v_mfma_f32_16x16x32_bf16 v[48:51], v[64:67], v[112:115], v[48:51]
    ds_read_b64 v[150:151], v4 offset:1032
    v_mfma_f32_16x16x32_bf16 v[52:55], v[68:71], v[112:115], v[52:55]
    ds_read_b128 v[180:183], v5 offset:2560
    v_mfma_f32_16x16x32_bf16 v[56:59], v[72:75], v[112:115], v[56:59]
    ds_read_b64 v[152:153], v4 offset:512
    v_mfma_f32_16x16x32_bf16 v[60:63], v[76:79], v[112:115], v[60:63]
    ds_read_b64 v[154:155], v4 offset:520
    v_mfma_f32_16x16x32_bf16 v[48:51], v[80:83], v[96:99], v[48:51]
    ds_read_b128 v[184:187], v5 offset:3072
    v_mfma_f32_16x16x32_bf16 v[52:55], v[80:83], v[100:103], v[52:55]
    ds_read_b64 v[156:157], v4 offset:0
    v_mfma_f32_16x16x32_bf16 v[56:59], v[80:83], v[104:107], v[56:59]
    ds_read_b64 v[158:159], v4 offset:8
    v_mfma_f32_16x16x32_bf16 v[60:63], v[80:83], v[108:111], v[60:63]
    ds_read_b128 v[188:191], v5 offset:3584
    v_mfma_f32_16x16x32_bf16 v[52:55], v[64:67], v[116:119], v[52:55]
    v_subrev_u32 v4, 64, v4
    v_mfma_f32_16x16x32_bf16 v[56:59], v[68:71], v[116:119], v[56:59]
    v_subrev_u32 v5, 64, v5
    v_mfma_f32_16x16x32_bf16 v[60:63], v[72:75], v[116:119], v[60:63]
    v_mfma_f32_16x16x32_bf16 v[52:55], v[84:87], v[96:99], v[52:55]
    v_mfma_f32_16x16x32_bf16 v[56:59], v[84:87], v[100:103], v[56:59]
    v_mfma_f32_16x16x32_bf16 v[60:63], v[84:87], v[104:107], v[60:63]
    v_mfma_f32_16x16x32_bf16 v[56:59], v[64:67], v[120:123], v[56:59]
    v_mfma_f32_16x16x32_bf16 v[60:63], v[68:71], v[120:123], v[60:63]
    v_mfma_f32_16x16x32_bf16 v[56:59], v[88:91], v[96:99], v[56:59]
    v_mfma_f32_16x16x32_bf16 v[60:63], v[88:91], v[100:103], v[60:63]
    v_mfma_f32_16x16x32_bf16 v[60:63], v[64:67], v[124:127], v[60:63]
    v_mfma_f32_16x16x32_bf16 v[60:63], v[92:95], v[96:99], v[60:63]
    s_waitcnt lgkmcnt(0)
    v_mfma_f32_16x16x32_bf16 v[32:35], v[128:131], v[160:163], v[32:35]
    ds_read_b64 v[64:65], v4 offset:3584
    v_mfma_f32_16x16x32_bf16 v[36:39], v[128:131], v[164:167], v[36:39]
    ds_read_b64 v[66:67], v4 offset:3592
    v_mfma_f32_16x16x32_bf16 v[36:39], v[132:135], v[160:163], v[36:39]
    ds_read_b128 v[96:99], v5 offset:0
    v_mfma_f32_16x16x32_bf16 v[40:43], v[132:135], v[164:167], v[40:43]
    ds_read_b64 v[68:69], v4 offset:3072
    v_mfma_f32_16x16x32_bf16 v[40:43], v[128:131], v[168:171], v[40:43]
    ds_read_b64 v[70:71], v4 offset:3080
    v_mfma_f32_16x16x32_bf16 v[44:47], v[132:135], v[168:171], v[44:47]
    ds_read_b128 v[100:103], v5 offset:512
    v_mfma_f32_16x16x32_bf16 v[40:43], v[136:139], v[160:163], v[40:43]
    ds_read_b64 v[72:73], v4 offset:2560
    v_mfma_f32_16x16x32_bf16 v[44:47], v[136:139], v[164:167], v[44:47]
    ds_read_b64 v[74:75], v4 offset:2568
    v_mfma_f32_16x16x32_bf16 v[48:51], v[136:139], v[168:171], v[48:51]
    ds_read_b128 v[104:107], v5 offset:1024
    v_mfma_f32_16x16x32_bf16 v[44:47], v[128:131], v[172:175], v[44:47]
    ds_read_b64 v[76:77], v4 offset:2048
    v_mfma_f32_16x16x32_bf16 v[48:51], v[132:135], v[172:175], v[48:51]
    ds_read_b64 v[78:79], v4 offset:2056
    v_mfma_f32_16x16x32_bf16 v[52:55], v[136:139], v[172:175], v[52:55]
    ds_read_b128 v[108:111], v5 offset:1536
    v_mfma_f32_16x16x32_bf16 v[44:47], v[140:143], v[160:163], v[44:47]
    ds_read_b64 v[80:81], v4 offset:1536
    v_mfma_f32_16x16x32_bf16 v[48:51], v[140:143], v[164:167], v[48:51]
    ds_read_b64 v[82:83], v4 offset:1544
    v_mfma_f32_16x16x32_bf16 v[52:55], v[140:143], v[168:171], v[52:55]
    ds_read_b128 v[112:115], v5 offset:2048
    v_mfma_f32_16x16x32_bf16 v[56:59], v[140:143], v[172:175], v[56:59]
    ds_read_b64 v[84:85], v4 offset:1024
    v_mfma_f32_16x16x32_bf16 v[48:51], v[128:131], v[176:179], v[48:51]
    ds_read_b64 v[86:87], v4 offset:1032
    v_mfma_f32_16x16x32_bf16 v[52:55], v[132:135], v[176:179], v[52:55]
    ds_read_b128 v[116:119], v5 offset:2560
    v_mfma_f32_16x16x32_bf16 v[56:59], v[136:139], v[176:179], v[56:59]
    ds_read_b64 v[88:89], v4 offset:512
    v_mfma_f32_16x16x32_bf16 v[60:63], v[140:143], v[176:179], v[60:63]
    ds_read_b64 v[90:91], v4 offset:520
    v_mfma_f32_16x16x32_bf16 v[48:51], v[144:147], v[160:163], v[48:51]
    ds_read_b128 v[120:123], v5 offset:3072
    v_mfma_f32_16x16x32_bf16 v[52:55], v[144:147], v[164:167], v[52:55]
    ds_read_b64 v[92:93], v4 offset:0
    v_mfma_f32_16x16x32_bf16 v[56:59], v[144:147], v[168:171], v[56:59]
    ds_read_b64 v[94:95], v4 offset:8
    v_mfma_f32_16x16x32_bf16 v[60:63], v[144:147], v[172:175], v[60:63]
    ds_read_b128 v[124:127], v5 offset:3584
    v_mfma_f32_16x16x32_bf16 v[52:55], v[128:131], v[180:183], v[52:55]
    v_subrev_u32 v4, 64, v4
    v_mfma_f32_16x16x32_bf16 v[56:59], v[132:135], v[180:183], v[56:59]
    v_subrev_u32 v5, 64, v5
    v_mfma_f32_16x16x32_bf16 v[60:63], v[136:139], v[180:183], v[60:63]
    v_mfma_f32_16x16x32_bf16 v[52:55], v[148:151], v[160:163], v[52:55]
    v_mfma_f32_16x16x32_bf16 v[56:59], v[148:151], v[164:167], v[56:59]
    v_mfma_f32_16x16x32_bf16 v[60:63], v[148:151], v[168:171], v[60:63]
    v_mfma_f32_16x16x32_bf16 v[56:59], v[128:131], v[184:187], v[56:59]
    v_mfma_f32_16x16x32_bf16 v[60:63], v[132:135], v[184:187], v[60:63]
    v_mfma_f32_16x16x32_bf16 v[56:59], v[152:155], v[160:163], v[56:59]
    v_mfma_f32_16x16x32_bf16 v[60:63], v[152:155], v[164:167], v[60:63]
    v_mfma_f32_16x16x32_bf16 v[60:63], v[128:131], v[188:191], v[60:63]
    v_mfma_f32_16x16x32_bf16 v[60:63], v[156:159], v[160:163], v[60:63]
    s_sub_u32 s15, s15, 1
    s_cmp_lg_u32 s15, 0
    s_cbranch_scc1 A_conv
    s_lshl_b32 s12, s9, 12
    s_add_u32 s12, s12, 33792
    v_add_u32 v24, s12, v23
    s_xor_b32 s13, s9, 1
    s_lshl_b32 s13, s13, 12
    s_add_u32 s13, s13, 33792
    v_add_u32 v26, s13, v23
    s_lshl_b32 s12, s9, 11
    s_add_u32 s12, s12, 50176
    v_lshlrev_b32 v28, 5, v27
    v_lshl_add_u32 v28, v25, 3, v28
    v_add_u32 v28, s12, v28
    v_add_u32 v6, s12, v23
    s_add_u32 s13, s62, 65536
    s_waitcnt lgkmcnt(0)
    s_cmp_lg_u32 s11, 0
    s_cbranch_scc1 A_r1
    ds_write_b128 v24, v[48:51] offset:0
    ds_write_b128 v24, v[52:55] offset:1024
    ds_write_b128 v24, v[56:59] offset:2048
    ds_write_b128 v24, v[60:63] offset:3072
    s_waitcnt lgkmcnt(0)
    s_barrier
    ds_read_b128 v[64:67], v26 offset:0
    ds_read_b128 v[68:71], v26 offset:1024
    ds_read_b128 v[72:75], v26 offset:2048
    ds_read_b128 v[76:79], v26 offset:3072
    s_waitcnt lgkmcnt(3)
    v_add_f32 v64, v64, v32
    v_add_f32 v65, v65, v33
    v_add_f32 v66, v66, v34
    v_add_f32 v67, v67, v35
    s_waitcnt lgkmcnt(2)
    v_add_f32 v68, v68, v36
    v_add_f32 v69, v69, v37
    v_add_f32 v70, v70, v38
    v_add_f32 v71, v71, v39
    s_waitcnt lgkmcnt(1)
    v_add_f32 v72, v72, v40
    v_add_f32 v73, v73, v41
    v_add_f32 v74, v74, v42
    v_add_f32 v75, v75, v43
    s_waitcnt lgkmcnt(0)
    v_add_f32 v76, v76, v44
    v_add_f32 v77, v77, v45
    v_add_f32 v78, v78, v46
    v_add_f32 v79, v79, v47
    s_branch A_r2
A_r1:
    ds_write_b128 v24, v[32:35] offset:0
    ds_write_b128 v24, v[36:39] offset:1024
    ds_write_b128 v24, v[40:43] offset:2048
    ds_write_b128 v24, v[44:47] offset:3072
    s_waitcnt lgkmcnt(0)
    s_barrier
    ds_read_b128 v[64:67], v26 offset:0
    ds_read_b128 v[68:71], v26 offset:1024
    ds_read_b128 v[72:75], v26 offset:2048
    ds_read_b128 v[76:79], v26 offset:3072
    s_waitcnt lgkmcnt(3)
    v_add_f32 v64, v64, v48
    v_add_f32 v65, v65, v49
    v_add_f32 v66, v66, v50
    v_add_f32 v67, v67, v51
    s_waitcnt lgkmcnt(2)
    v_add_f32 v68, v68, v52
    v_add_f32 v69, v69, v53
    v_add_f32 v70, v70, v54
    v_add_f32 v71, v71, v55
    s_waitcnt lgkmcnt(1)
    v_add_f32 v72, v72, v56
    v_add_f32 v73, v73, v57
    v_add_f32 v74, v74, v58
    v_add_f32 v75, v75, v59
    s_waitcnt lgkmcnt(0)
    v_add_f32 v76, v76, v60
    v_add_f32 v77, v77, v61
    v_add_f32 v78, v78, v62
    v_add_f32 v79, v79, v63
A_r2:
    v_cvt_pk_bf16_f32 v80, v64, v65
    v_cvt_pk_bf16_f32 v81, v66, v67
    ds_write_b64 v28, v[80:81] offset:0
    v_cvt_pk_bf16_f32 v82, v68, v69
    v_cvt_pk_bf16_f32 v83, v70, v71
    ds_write_b64 v28, v[82:83] offset:512
    v_cvt_pk_bf16_f32 v84, v72, v73
    v_cvt_pk_bf16_f32 v85, v74, v75
    ds_write_b64 v28, v[84:85] offset:1024
    v_cvt_pk_bf16_f32 v86, v76, v77
    v_cvt_pk_bf16_f32 v87, v78, v79
    ds_write_b64 v28, v[86:87] offset:1536
    ds_read_b128 v[88:91], v6
    ds_read_b128 v[92:95], v6 offset:1024
    s_cmp_eq_u32 s59, 0
    s_cbranch_scc1 A_s0
    s_waitcnt lgkmcnt(1)
    buffer_store_dwordx4 v[88:91], v22, s[40:43], s62 offen
    s_waitcnt lgkmcnt(0)
    buffer_store_dwordx4 v[92:95], v22, s[40:43], s13 offen
    s_branch A_s1
A_s0:
    s_waitcnt lgkmcnt(1)
    buffer_store_dwordx4 v[88:91], v22, s[40:43], s62 offen sc1
    s_waitcnt lgkmcnt(0)
    buffer_store_dwordx4 v[92:95], v22, s[40:43], s13 offen sc1
A_s1:
    v_lshrrev_b32 v24, 3, v1
    v_xor_b32 v26, v24, v1
    v_and_b32 v26, 7, v26
    v_lshlrev_b32 v24, 7, v24
    v_lshl_add_u32 v24, v26, 4, v24
    v_and_b32 v26, 7, v27
    v_lshlrev_b32 v26, 4, v26
    v_lshl_add_u32 v26, v27, 7, v26
    v_lshl_add_u32 v26, v25, 1, v26
    s_lshl_b32 s69, s9, 11
    v_add_u32 v8, s69, v26
    v_xor_b32 v9, 16, v8
    v_xor_b32 v10, 32, v8
    v_xor_b32 v11, 48, v8
    v_xor_b32 v12, 64, v8
    v_xor_b32 v13, 80, v8
    v_xor_b32 v14, 96, v8
    v_xor_b32 v15, 112, v8
    s_mov_b32 m0, s69
    v_mul_u32_u24 v5, 3584, v25
    v_lshl_add_u32 v5, v27, 4, v5
    v_mov_b32 v32, 0
    v_mov_b32 v33, 0
    v_mov_b32 v34, 0
    v_mov_b32 v35, 0
    v_mov_b32 v36, 0
    v_mov_b32 v37, 0
    v_mov_b32 v38, 0
    v_mov_b32 v39, 0
    v_mov_b32 v40, 0
    v_mov_b32 v41, 0
    v_mov_b32 v42, 0
    v_mov_b32 v43, 0
    v_mov_b32 v44, 0
    v_mov_b32 v45, 0
    v_mov_b32 v46, 0
    v_mov_b32 v47, 0
    s_lshl_b32 s12, s5, 11
    s_add_u32 s12, s12, 0xd000
    v_lshl_add_u32 v6, v31, 6, s12
    s_waitcnt vmcnt(0)
    s_barrier
    s_cmp_lg_u32 s9, 0
    s_cbranch_scc1 A_apok
    s_lshl_b32 s13, 1, s6
    s_mov_b32 exec_lo, s13
    s_mov_b32 exec_hi, 0
    v_mov_b32 v7, s14
    s_cmp_eq_u32 s59, 0
    s_cbranch_scc1 A_f0
    global_store_dword v6, v7, s[38:39]
    s_branch A_f1
A_f0:
    global_store_dword v6, v7, s[38:39] sc1
A_f1:
    s_mov_b64 exec, -1
A_ap:
    s_sub_u32 s98, s98, 1
    s_cbranch_scc1 L_exit
    global_load_dword v7, v6, s[38:39] sc1
    s_waitcnt vmcnt(0)
    v_cmp_ne_u32 vcc, s14, v7
    s_and_b64 exec, exec, vcc
    s_cbranch_execnz A_ap
    s_mov_b64 exec, -1
A_apok:
    s_lshl_b32 s12, s6, 13
    s_add_u32 s12, s12, s69
    s_barrier
    buffer_load_dwordx4 v24, s[40:43], s12 offen sc1 lds
    buffer_load_dwordx4 v24, s[40:43], s12 offen offset:1024 sc1 lds
    s_lshl_b32 s12, s6, 6
    s_lshl_b32 s13, s9, 4
    s_add_u32 s12, s12, s13
    s_mul_i32 s12, s12, 3584
    s_lshl_b32 s13, s5, 8
    s_add_u32 s12, s12, s13
    s_waitcnt vmcnt(0)
    ds_read_u16_d16_hi v32, v8 offset:0
    ds_read_u16_d16_hi v33, v9 offset:0
    ds_read_u16_d16_hi v34, v12 offset:0
    ds_read_u16_d16_hi v35, v13 offset:0
    ds_read_u16_d16_hi v36, v8 offset:8
    ds_read_u16_d16_hi v37, v9 offset:8
    ds_read_u16_d16_hi v38, v12 offset:8
    ds_read_u16_d16_hi v39, v13 offset:8
    ds_read_u16_d16_hi v40, v10 offset:0
    ds_read_u16_d16_hi v41, v11 offset:0
    ds_read_u16_d16_hi v42, v14 offset:0
    ds_read_u16_d16_hi v43, v15 offset:0
    s_waitcnt lgkmcnt(8)
    buffer_store_dwordx4 v[32:35], v5, s[48:51], s12 offen nt
    s_add_u32 s12, s12, 14336
    ds_read_u16_d16_hi v44, v10 offset:8
    ds_read_u16_d16_hi v45, v11 offset:8
    ds_read_u16_d16_hi v46, v14 offset:8
    ds_read_u16_d16_hi v47, v15 offset:8
    s_waitcnt lgkmcnt(8)
    buffer_store_dwordx4 v[36:39], v5, s[48:51], s12 offen nt
    s_add_u32 s12, s12, 14336
    s_waitcnt lgkmcnt(4)
    buffer_store_dwordx4 v[40:43], v5, s[48:51], s12 offen nt
    s_add_u32 s12, s12, 14336
    s_waitcnt lgkmcnt(0)
    buffer_store_dwordx4 v[44:47], v5, s[48:51], s12 offen nt
    s_add_u32 s12, s12, 14336
    s_endpgm
B_rest:
    s_add_u32 s82, s12, s8
    s_add_u32 s89, s13, s8
    s_add_u32 s8, s8, 128
    s_cmp_eq_u32 s8, 896
    s_cselect_b32 s8, 0, s8
    s_add_u32 s83, s12, s8
    s_add_u32 s90, s13, s8
    s_add_u32 s8, s8, 128
    s_cmp_eq_u32 s8, 896
    s_cselect_b32 s8, 0, s8
    s_add_u32 s84, s12, s8
    s_add_u32 s91, s13, s8
    s_add_u32 s8, s8, 128
    s_cmp_eq_u32 s8, 896
    s_cselect_b32 s8, 0, s8
    s_add_u32 s85, s12, s8
    s_add_u32 s92, s13, s8
    s_add_u32 s8, s8, 128
    s_cmp_eq_u32 s8, 896
    s_cselect_b32 s8, 0, s8
    s_add_u32 s86, s12, s8
    s_add_u32 s93, s13, s8
    s_add_u32 s8, s8, 128
    s_cmp_eq_u32 s8, 896
    s_cselect_b32 s8, 0, s8
    s_add_u32 s87, s12, s8
    s_add_u32 s94, s13, s8
    s_sub_u32 s52, s26, 0x1000
    s_subb_u32 s53, s27, 0
    s_and_b32 s53, s53, 0xffff
    s_mov_b32 s54, 0x63000
    s_mov_b32 s55, 0x20000
    s_sub_u32 s56, s28, 0x1000
    s_subb_u32 s57, s29, 0
    s_and_b32 s57, s57, 0xffff
    s_mov_b32 s58, 0x63000
    s_mov_b32 s59, 0x20000
    s_mov_b32 s60, s34
    s_and_b32 s61, s35, 0xffff
    s_mov_b32 s62, 0x700000
    s_mov_b32 s63, 0x20000
    s_lshl_b32 s14, s6, 1
    s_add_u32 s14, s14, s11
    s_lshl_b32 s14, s14, 13
    s_add_u32 s14, s14, 0x20000
    s_add_u32 s64, s38, s14
    s_addc_u32 s65, s39, 0
    s_and_b32 s65, s65, 0xffff
    s_mov_b32 s66, 0x2000
    s_mov_b32 s67, 0x20000
    s_mul_i32 s14, s7, 114688
    s_add_u32 s14, s14, 0x100000
    s_add_u32 s68, s38, s14
    s_addc_u32 s69, s39, 0
    s_and_b32 s69, s69, 0xffff
    s_mov_b32 s70, 0x1c000
    s_mov_b32 s71, 0x20000
    s_lshl_b32 s16, s6, 7
    s_mul_i32 s14, s5, 13
    s_add_u32 s14, s14, 4
    s_lshr_b32 s14, s14, 3
    s_lshl_b32 s14, s14, 7
    s_add_u32 s14, s14, s16
    s_add_u32 s14, s14, 128
    s_sub_u32 s15, s14, 896
    s_cmp_ge_u32 s14, 896
    s_cselect_b32 s14, s15, s14
    s_mov_b32 s17, s14
    s_add_u32 s14, s14, 128
    s_sub_u32 s15, s14, 896
    s_cmp_ge_u32 s14, 896
    s_cselect_b32 s14, s15, s14
    s_cmp_eq_u32 s14, s16
    s_cselect_b32 s15, 128, 0
    s_add_u32 s14, s14, s15
    s_cmp_eq_u32 s14, 896
    s_cselect_b32 s14, 0, s14
    s_mov_b32 s18, s14
    s_add_u32 s14, s14, 128
    s_sub_u32 s15, s14, 896
    s_cmp_ge_u32 s14, 896
    s_cselect_b32 s14, s15, s14
    s_cmp_eq_u32 s14, s16
    s_cselect_b32 s15, 128, 0
    s_add_u32 s14, s14, s15
    s_cmp_eq_u32 s14, 896
    s_cselect_b32 s14, 0, s14
    s_mov_b32 s19, s14
    s_add_u32 s14, s14, 128
    s_sub_u32 s15, s14, 896
    s_cmp_ge_u32 s14, 896
    s_cselect_b32 s14, s15, s14
    s_cmp_eq_u32 s14, s16
    s_cselect_b32 s15, 128, 0
    s_add_u32 s14, s14, s15
    s_cmp_eq_u32 s14, 896
    s_cselect_b32 s14, 0, s14
    s_mov_b32 s20, s14
    s_add_u32 s14, s14, 128
    s_sub_u32 s15, s14, 896
    s_cmp_ge_u32 s14, 896
    s_cselect_b32 s14, s15, s14
    s_cmp_eq_u32 s14, s16
    s_cselect_b32 s15, 128, 0
    s_add_u32 s14, s14, s15
    s_cmp_eq_u32 s14, 896
    s_cselect_b32 s14, 0, s14
    s_mov_b32 s21, s14
    s_add_u32 s14, s14, 128
    s_sub_u32 s15, s14, 896
    s_cmp_ge_u32 s14, 896
    s_cselect_b32 s14, s15, s14
    s_cmp_eq_u32 s14, s16
    s_cselect_b32 s15, 128, 0
    s_add_u32 s14, s14, s15
    s_cmp_eq_u32 s14, 896
    s_cselect_b32 s14, 0, s14
    s_mov_b32 s22, s14
    s_lshl_b32 s23, s16, 7
    s_add_u32 s16, s16, s13
    s_lshl_b32 s24, s17, 7
    s_add_u32 s17, s17, s13
    s_lshl_b32 s25, s18, 7
    s_add_u32 s18, s18, s13
    s_lshl_b32 s26, s19, 7
    s_add_u32 s19, s19, s13
    s_lshl_b32 s27, s20, 7
    s_add_u32 s20, s20, s13
    s_lshl_b32 s28, s21, 7
    s_add_u32 s21, s21, s13
    s_lshl_b32 s29, s22, 7
    s_add_u32 s22, s22, s13
    s_mov_b32 s74, 0
    s_mov_b32 s75, -1
    s_getreg_b32 s77, hwreg(HW_REG_XCC_ID)
    v_and_b32 v30, 31, v1
    v_lshrrev_b32 v31, 5, v1
    v_bfe_u32 v67, v30, 2, 1
    v_lshlrev_b32 v67, 4, v67
    v_lshrrev_b32 v68, 3, v30
    v_lshl_add_u32 v67, v68, 1, v67
    v_bfe_u32 v68, v30, 1, 1
    v_add_u32 v67, v67, v68
    v_and_b32 v68, 1, v30
    v_lshl_add_u32 v67, v68, 3, v67
    s_lshl_b32 s14, s10, 5
    v_add_u32 v67, s14, v67
    v_bfe_u32 v68, v67, 1, 3
    v_xor_b32 v68, v68, v31
    v_lshlrev_b32 v68, 4, v68
    v_lshl_add_u32 v4, v67, 7, v68
    v_lshrrev_b32 v67, 4, v67
    v_lshl_add_u32 v4, v67, 12, v4
    s_lshl_b32 s14, s11, 5
    v_add_u32 v67, s14, v30
    v_bfe_u32 v68, v67, 1, 3
    v_xor_b32 v68, v68, v31
    v_lshlrev_b32 v68, 4, v68
    v_lshl_add_u32 v8, v67, 7, v68
    v_lshrrev_b32 v67, 4, v67
    v_lshl_add_u32 v8, v67, 12, v8
    v_add_u32 v8, 2048, v8
    v_xor_b32 v5, 32, v4
    v_xor_b32 v9, 32, v8
    v_xor_b32 v6, 64, v4
    v_xor_b32 v10, 64, v8
    v_xor_b32 v7, 96, v4
    v_xor_b32 v11, 96, v8
    s_lshl_b32 s14, s10, 1
    v_add_u32 v31, s14, v31
    v_lshrrev_b32 v67, 4, v1
    v_bfe_u32 v68, v1, 3, 1
    s_lshl_b32 s14, s9, 1
    v_add_u32 v68, s14, v68
    v_xor_b32 v68, v68, v67
    v_lshlrev_b32 v68, 4, v68
    v_lshl_add_u32 v68, v67, 8, v68
    v_and_b32 v76, 7, v1
    v_lshl_add_u32 v30, v76, 1, v68
    v_xor_b32 v31, 64, v30
    v_lshlrev_b32 v136, 4, v1
    v_mov_b32 v240, 0
    v_mov_b32 v241, 0
    v_mov_b32 v242, 0
    v_mov_b32 v243, 0
    v_mov_b32 v244, 0
    v_mov_b32 v245, 0
    v_mov_b32 v246, 0
    v_mov_b32 v247, 0
    v_mov_b32 v248, 0
    v_mov_b32 v249, 0
    v_mov_b32 v250, 0
    v_mov_b32 v251, 0
    v_mov_b32 v252, 0
    v_mov_b32 v253, 0
    v_mov_b32 v254, 0
    v_mov_b32 v255, 0
    s_lshl_b32 s79, s6, 14
    s_lshl_b32 s80, s9, 12
    s_add_u32 s79, s79, s80
    buffer_load_dwordx4 v[224:227], v136, s[68:71], s79 offen offset:0
    buffer_load_dwordx4 v[228:231], v136, s[68:71], s79 offen offset:1024
    buffer_load_dwordx4 v[232:235], v136, s[68:71], s79 offen offset:2048
    buffer_load_dwordx4 v[236:239], v136, s[68:71], s79 offen offset:3072
    s_waitcnt vmcnt(10)
    s_add_u32 m0, s73, 24576
    s_nop 0
    buffer_load_dwordx4 v2, s[40:43], s82 offen lds
    buffer_load_dwordx4 v3, s[40:43], s82 offen offset:1024 lds
    buffer_load_dwordx4 v137, s[44:47], s89 offen offset:2048 lds
    buffer_load_dwordx4 v138, s[44:47], s89 offen offset:3072 lds
    s_add_u32 m0, m0, 4096
    s_nop 0
    buffer_load_dwordx4 v2, s[48:51], s89 offen lds
    buffer_load_dwordx4 v3, s[48:51], s89 offen offset:1024 lds
    v_lshlrev_b32 v146, 16, v146
    v_mul_f32 v146, 0x3fb8aa3b, v146
    v_lshlrev_b32 v140, 16, v140
    v_exp_f32 v146, v146
    v_lshlrev_b32 v141, 16, v141
    v_lshlrev_b32 v28, 16, v28
    v_cvt_pk_bf16_f32 v146, v146, v146
    v_lshlrev_b32 v146, 16, v146
    v_mul_f32 v142, v146, v140
    v_mul_f32 v143, v146, v141
    v_mul_f32 v142, 0x3fb8aa3b, v142
    v_mul_f32 v143, 0.15915494, v143
    v_mul_f32 v154, 0x41000000, v142
    v_mul_f32 v156, 0x41800000, v142
    v_exp_f32 v152, v142
    v_mul_f32 v155, 0x41000000, v143
    v_mul_f32 v157, 0x41800000, v143
    v_fract_f32 v153, v143
    v_exp_f32 v154, v154
    v_exp_f32 v156, v156
    v_cos_f32 v12, v153
    v_fract_f32 v155, v155
    v_fract_f32 v157, v157
    v_sin_f32 v13, v153
    v_cos_f32 v128, v155
    v_cos_f32 v18, v157
    v_mul_f32 v12, v12, v152
    v_sin_f32 v129, v155
    v_sin_f32 v19, v157
    v_mul_f32 v13, v13, v152
    v_mul_f32 v128, v128, v154
    v_mul_f32 v18, v18, v156
    v_sub_f32 v14, 0, v13
    v_mul_f32 v129, v129, v154
    v_mul_f32 v19, v19, v156
    s_waitcnt vmcnt(10)
    s_barrier
    ds_read_b128 v[64:67], v4 offset:0
    ds_read_b128 v[68:71], v8 offset:0
    ds_read_b128 v[72:75], v8 offset:2048
    ds_read_b128 v[76:79], v5 offset:0
    ds_read_b128 v[80:83], v9 offset:0
    ds_read_b128 v[84:87], v9 offset:2048
    ds_read_b128 v[88:91], v6 offset:0
    ds_read_b128 v[92:95], v10 offset:0
    ds_read_b128 v[96:99], v10 offset:2048
    ds_read_b128 v[100:103], v7 offset:0
    ds_read_b128 v[104:107], v11 offset:0
    ds_read_b128 v[108:111], v11 offset:2048
    v_add_u32 v147, 4096, v136
    s_add_u32 m0, s73, 49152
    s_nop 0
    buffer_load_dwordx4 v2, s[40:43], s83 offen lds
    buffer_load_dwordx4 v3, s[40:43], s83 offen offset:1024 lds
    s_waitcnt lgkmcnt(9)
    v_mfma_f32_32x32x16_bf16 v[32:47], v[64:67], v[68:71], 0
    v_mfma_f32_32x32x16_bf16 v[48:63], v[64:67], v[72:75], 0
    buffer_load_dwordx4 v137, s[44:47], s90 offen offset:2048 lds
    buffer_load_dwordx4 v138, s[44:47], s90 offen offset:3072 lds
    s_waitcnt lgkmcnt(6)
    v_mfma_f32_32x32x16_bf16 v[32:47], v[76:79], v[80:83], v[32:47]
    v_mfma_f32_32x32x16_bf16 v[48:63], v[76:79], v[84:87], v[48:63]
    s_add_u32 m0, m0, 4096
    s_nop 0
    buffer_load_dwordx4 v2, s[48:51], s90 offen lds
    buffer_load_dwordx4 v3, s[48:51], s90 offen offset:1024 lds
    s_and_b32 s14, s5, 2
    s_cmp_lg_u32 s14, 0
    s_cbranch_scc1 B_nosk0
    ds_read_u16_d16_hi v240, v30 offset:0
    ds_read_u16_d16_hi v241, v31 offset:1024
    ds_read_u16_d16_hi v242, v30 offset:128
    ds_read_u16_d16_hi v243, v31 offset:1152
    ds_read_u16_d16_hi v244, v30 offset:6144
    ds_read_u16_d16_hi v245, v31 offset:7168
    ds_read_u16_d16_hi v246, v30 offset:6272
    ds_read_u16_d16_hi v247, v31 offset:7296
    ds_read_u16_d16_hi v248, v30 offset:12288
    ds_read_u16_d16_hi v249, v31 offset:13312
    ds_read_u16_d16_hi v250, v30 offset:12416
    ds_read_u16_d16_hi v251, v31 offset:13440
    ds_read_u16_d16_hi v252, v30 offset:18432
    ds_read_u16_d16_hi v253, v31 offset:19456
    ds_read_u16_d16_hi v254, v30 offset:18560
    ds_read_u16_d16_hi v255, v31 offset:19584
B_nosk0:
    s_waitcnt vmcnt(6) lgkmcnt(0)
    s_barrier
    v_mfma_f32_32x32x16_bf16 v[32:47], v[88:91], v[92:95], v[32:47]
    ds_read_b128 v[64:67], v4 offset:24576
    ds_read_b128 v[68:71], v8 offset:24576
    ds_read_b128 v[72:75], v8 offset:26624
    v_mfma_f32_32x32x16_bf16 v[48:63], v[88:91], v[96:99], v[48:63]
    ds_read_b128 v[76:79], v5 offset:24576
    ds_read_b128 v[80:83], v9 offset:24576
    ds_read_b128 v[84:87], v9 offset:26624
    v_mfma_f32_32x32x16_bf16 v[32:47], v[100:103], v[104:107], v[32:47]
    ds_read_b128 v[88:91], v6 offset:24576
    ds_read_b128 v[92:95], v10 offset:24576
    ds_read_b128 v[96:99], v10 offset:26624
    v_mfma_f32_32x32x16_bf16 v[48:63], v[100:103], v[108:111], v[48:63]
    ds_read_b128 v[100:103], v7 offset:24576
    ds_read_b128 v[104:107], v11 offset:24576
    ds_read_b128 v[108:111], v11 offset:26624
    s_add_u32 m0, s73, 0
    s_nop 0
    buffer_load_dwordx4 v2, s[40:43], s84 offen lds
    buffer_load_dwordx4 v3, s[40:43], s84 offen offset:1024 lds
    s_waitcnt lgkmcnt(9)
    v_mfma_f32_32x32x16_bf16 v[32:47], v[64:67], v[68:71], v[32:47]
    v_mfma_f32_32x32x16_bf16 v[48:63], v[64:67], v[72:75], v[48:63]
    buffer_load_dwordx4 v137, s[44:47], s91 offen offset:2048 lds
    buffer_load_dwordx4 v138, s[44:47], s91 offen offset:3072 lds
    s_waitcnt lgkmcnt(6)
    v_mfma_f32_32x32x16_bf16 v[32:47], v[76:79], v[80:83], v[32:47]
    v_mfma_f32_32x32x16_bf16 v[48:63], v[76:79], v[84:87], v[48:63]
    s_add_u32 m0, m0, 4096
    s_nop 0
    buffer_load_dwordx4 v2, s[48:51], s91 offen lds
    buffer_load_dwordx4 v3, s[48:51], s91 offen offset:1024 lds
    s_waitcnt vmcnt(6) lgkmcnt(0)
    s_barrier
    v_mfma_f32_32x32x16_bf16 v[32:47], v[88:91], v[92:95], v[32:47]
    ds_read_b128 v[64:67], v4 offset:49152
    ds_read_b128 v[68:71], v8 offset:49152
    ds_read_b128 v[72:75], v8 offset:51200
    v_mfma_f32_32x32x16_bf16 v[48:63], v[88:91], v[96:99], v[48:63]
    ds_read_b128 v[76:79], v5 offset:49152
    ds_read_b128 v[80:83], v9 offset:49152
    ds_read_b128 v[84:87], v9 offset:51200
    v_mfma_f32_32x32x16_bf16 v[32:47], v[100:103], v[104:107], v[32:47]
    ds_read_b128 v[88:91], v6 offset:49152
    ds_read_b128 v[92:95], v10 offset:49152
    ds_read_b128 v[96:99], v10 offset:51200
    v_mfma_f32_32x32x16_bf16 v[48:63], v[100:103], v[108:111], v[48:63]
    ds_read_b128 v[100:103], v7 offset:49152
    ds_read_b128 v[104:107], v11 offset:49152
    ds_read_b128 v[108:111], v11 offset:51200
    global_load_dword v29, v15, s[36:37] sc1
    s_add_u32 m0, s73, 24576
    s_nop 0
    buffer_load_dwordx4 v2, s[40:43], s85 offen lds
    buffer_load_dwordx4 v3, s[40:43], s85 offen offset:1024 lds
    s_waitcnt lgkmcnt(9)
    v_mfma_f32_32x32x16_bf16 v[32:47], v[64:67], v[68:71], v[32:47]
    v_mfma_f32_32x32x16_bf16 v[48:63], v[64:67], v[72:75], v[48:63]
    buffer_load_dwordx4 v137, s[44:47], s92 offen offset:2048 lds
    buffer_load_dwordx4 v138, s[44:47], s92 offen offset:3072 lds
    s_waitcnt lgkmcnt(6)
    v_mfma_f32_32x32x16_bf16 v[32:47], v[76:79], v[80:83], v[32:47]
    v_mfma_f32_32x32x16_bf16 v[48:63], v[76:79], v[84:87], v[48:63]
    s_add_u32 m0, m0, 4096
    s_nop 0
    buffer_load_dwordx4 v2, s[48:51], s92 offen lds
    buffer_load_dwordx4 v3, s[48:51], s92 offen offset:1024 lds
    s_waitcnt vmcnt(7) lgkmcnt(0)
    s_barrier
    v_mfma_f32_32x32x16_bf16 v[32:47], v[88:91], v[92:95], v[32:47]
    ds_read_b128 v[64:67], v4 offset:0
    ds_read_b128 v[68:71], v8 offset:0
    ds_read_b128 v[72:75], v8 offset:2048
    v_mfma_f32_32x32x16_bf16 v[48:63], v[88:91], v[96:99], v[48:63]
    ds_read_b128 v[76:79], v5 offset:0
    ds_read_b128 v[80:83], v9 offset:0
    ds_read_b128 v[84:87], v9 offset:2048
    v_mfma_f32_32x32x16_bf16 v[32:47], v[100:103], v[104:107], v[32:47]
    ds_read_b128 v[88:91], v6 offset:0
    ds_read_b128 v[92:95], v10 offset:0
    ds_read_b128 v[96:99], v10 offset:2048
    v_mfma_f32_32x32x16_bf16 v[48:63], v[100:103], v[108:111], v[48:63]
    ds_read_b128 v[100:103], v7 offset:0
    ds_read_b128 v[104:107], v11 offset:0
    ds_read_b128 v[108:111], v11 offset:2048
    s_add_u32 m0, s73, 49152
    s_nop 0
    buffer_load_dwordx4 v2, s[40:43], s86 offen lds
    buffer_load_dwordx4 v3, s[40:43], s86 offen offset:1024 lds
    s_waitcnt lgkmcnt(9)
    v_mfma_f32_32x32x16_bf16 v[32:47], v[64:67], v[68:71], v[32:47]
    v_mfma_f32_32x32x16_bf16 v[48:63], v[64:67], v[72:75], v[48:63]
    buffer_load_dwordx4 v137, s[44:47], s93 offen offset:2048 lds
    buffer_load_dwordx4 v138, s[44:47], s93 offen offset:3072 lds
    s_waitcnt lgkmcnt(6)
    v_mfma_f32_32x32x16_bf16 v[32:47], v[76:79], v[80:83], v[32:47]
    v_mfma_f32_32x32x16_bf16 v[48:63], v[76:79], v[84:87], v[48:63]
    s_add_u32 m0, m0, 4096
    s_nop 0
    buffer_load_dwordx4 v2, s[48:51], s93 offen lds
    buffer_load_dwordx4 v3, s[48:51], s93 offen offset:1024 lds
    s_and_b32 s14, s5, 2
    s_cmp_lg_u32 s14, 2
    s_cbranch_scc1 B_nosk3
    ds_read_u16_d16_hi v240, v30 offset:0
    ds_read_u16_d16_hi v241, v31 offset:1024
    ds_read_u16_d16_hi v242, v30 offset:128
    ds_read_u16_d16_hi v243, v31 offset:1152
    ds_read_u16_d16_hi v244, v30 offset:6144
    ds_read_u16_d16_hi v245, v31 offset:7168
    ds_read_u16_d16_hi v246, v30 offset:6272
    ds_read_u16_d16_hi v247, v31 offset:7296
    ds_read_u16_d16_hi v248, v30 offset:12288
    ds_read_u16_d16_hi v249, v31 offset:13312
    ds_read_u16_d16_hi v250, v30 offset:12416
    ds_read_u16_d16_hi v251, v31 offset:13440
    ds_read_u16_d16_hi v252, v30 offset:18432
    ds_read_u16_d16_hi v253, v31 offset:19456
    ds_read_u16_d16_hi v254, v30 offset:18560
    ds_read_u16_d16_hi v255, v31 offset:19584
B_nosk3:
    s_waitcnt vmcnt(6) lgkmcnt(0)
    s_barrier
    v_mfma_f32_32x32x16_bf16 v[32:47], v[88:91], v[92:95], v[32:47]
    ds_read_b128 v[64:67], v4 offset:24576
    ds_read_b128 v[68:71], v8 offset:24576
    ds_read_b128 v[72:75], v8 offset:26624
    v_mfma_f32_32x32x16_bf16 v[48:63], v[88:91], v[96:99], v[48:63]
    ds_read_b128 v[76:79], v5 offset:24576
    ds_read_b128 v[80:83], v9 offset:24576
    ds_read_b128 v[84:87], v9 offset:26624
    v_mfma_f32_32x32x16_bf16 v[32:47], v[100:103], v[104:107], v[32:47]
    ds_read_b128 v[88:91], v6 offset:24576
    ds_read_b128 v[92:95], v10 offset:24576
    ds_read_b128 v[96:99], v10 offset:26624
    v_mfma_f32_32x32x16_bf16 v[48:63], v[100:103], v[108:111], v[48:63]
    ds_read_b128 v[100:103], v7 offset:24576
    ds_read_b128 v[104:107], v11 offset:24576
    ds_read_b128 v[108:111], v11 offset:26624
    s_add_u32 m0, s73, 0
    s_nop 0
    buffer_load_dwordx4 v2, s[40:43], s87 offen lds
    buffer_load_dwordx4 v3, s[40:43], s87 offen offset:1024 lds
    s_waitcnt lgkmcnt(9)
    v_mfma_f32_32x32x16_bf16 v[32:47], v[64:67], v[68:71], v[32:47]
    v_mfma_f32_32x32x16_bf16 v[48:63], v[64:67], v[72:75], v[48:63]
    buffer_load_dwordx4 v137, s[44:47], s94 offen offset:2048 lds
    buffer_load_dwordx4 v138, s[44:47], s94 offen offset:3072 lds
    s_waitcnt lgkmcnt(6)
    v_mfma_f32_32x32x16_bf16 v[32:47], v[76:79], v[80:83], v[32:47]
    v_mfma_f32_32x32x16_bf16 v[48:63], v[76:79], v[84:87], v[48:63]
    s_add_u32 m0, m0, 4096
    s_nop 0
    buffer_load_dwordx4 v2, s[48:51], s94 offen lds
    buffer_load_dwordx4 v3, s[48:51], s94 offen offset:1024 lds
    s_waitcnt vmcnt(6) lgkmcnt(0)
    s_barrier
    v_mfma_f32_32x32x16_bf16 v[32:47], v[88:91], v[92:95], v[32:47]
    ds_read_b128 v[64:67], v4 offset:49152
    ds_read_b128 v[68:71], v8 offset:49152
    ds_read_b128 v[72:75], v8 offset:51200
    v_mfma_f32_32x32x16_bf16 v[48:63], v[88:91], v[96:99], v[48:63]
    ds_read_b128 v[76:79], v5 offset:49152
    ds_read_b128 v[80:83], v9 offset:49152
    ds_read_b128 v[84:87], v9 offset:51200
    v_mfma_f32_32x32x16_bf16 v[32:47], v[100:103], v[104:107], v[32:47]
    ds_read_b128 v[88:91], v6 offset:49152
    ds_read_b128 v[92:95], v10 offset:49152
    ds_read_b128 v[96:99], v10 offset:51200
    v_mfma_f32_32x32x16_bf16 v[48:63], v[100:103], v[108:111], v[48:63]
    ds_read_b128 v[100:103], v7 offset:49152
    ds_read_b128 v[104:107], v11 offset:49152
    ds_read_b128 v[108:111], v11 offset:51200
    s_waitcnt lgkmcnt(9)
    v_mfma_f32_32x32x16_bf16 v[32:47], v[64:67], v[68:71], v[32:47]
    v_mfma_f32_32x32x16_bf16 v[48:63], v[64:67], v[72:75], v[48:63]
    s_waitcnt lgkmcnt(6)
    v_mfma_f32_32x32x16_bf16 v[32:47], v[76:79], v[80:83], v[32:47]
    v_mfma_f32_32x32x16_bf16 v[48:63], v[76:79], v[84:87], v[48:63]
    s_waitcnt vmcnt(0) lgkmcnt(0)
    s_barrier
    v_readfirstlane_b32 s72, v29
    s_cmp_lg_u32 s72, 0
    s_cbranch_scc1 B_ep_ok
B_ep_retry:
    s_sub_u32 s98, s98, 1
    s_cbranch_scc1 L_exit
    s_sleep 1
    global_load_dword v29, v15, s[36:37] sc1
    s_waitcnt vmcnt(0)
    v_readfirstlane_b32 s72, v29
    s_cmp_eq_u32 s72, 0
    s_cbranch_scc1 B_ep_retry
B_ep_ok:
    v_mfma_f32_32x32x16_bf16 v[32:47], v[88:91], v[92:95], v[32:47]
    ds_read_b128 v[64:67], v4 offset:0
    ds_read_b128 v[68:71], v8 offset:0
    ds_read_b128 v[72:75], v8 offset:2048
    v_mfma_f32_32x32x16_bf16 v[48:63], v[88:91], v[96:99], v[48:63]
    ds_read_b128 v[76:79], v5 offset:0
    ds_read_b128 v[80:83], v9 offset:0
    ds_read_b128 v[84:87], v9 offset:2048
    v_mfma_f32_32x32x16_bf16 v[32:47], v[100:103], v[104:107], v[32:47]
    ds_read_b128 v[88:91], v6 offset:0
    ds_read_b128 v[92:95], v10 offset:0
    ds_read_b128 v[96:99], v10 offset:2048
    v_mfma_f32_32x32x16_bf16 v[48:63], v[100:103], v[108:111], v[48:63]
    ds_read_b128 v[100:103], v7 offset:0
    ds_read_b128 v[104:107], v11 offset:0
    ds_read_b128 v[108:111], v11 offset:2048
    s_waitcnt lgkmcnt(9)
    v_mfma_f32_32x32x16_bf16 v[32:47], v[64:67], v[68:71], v[32:47]
    v_mfma_f32_32x32x16_bf16 v[48:63], v[64:67], v[72:75], v[48:63]
    s_waitcnt lgkmcnt(6)
    v_mfma_f32_32x32x16_bf16 v[32:47], v[76:79], v[80:83], v[32:47]
    v_mfma_f32_32x32x16_bf16 v[48:63], v[76:79], v[84:87], v[48:63]
    s_waitcnt lgkmcnt(3)
    v_mfma_f32_32x32x16_bf16 v[32:47], v[88:91], v[92:95], v[32:47]
    v_mfma_f32_32x32x16_bf16 v[48:63], v[88:91], v[96:99], v[48:63]
    s_waitcnt lgkmcnt(0)
    v_mfma_f32_32x32x16_bf16 v[32:47], v[100:103], v[104:107], v[32:47]
    v_mfma_f32_32x32x16_bf16 v[48:63], v[100:103], v[108:111], v[48:63]
    s_setprio 3
    v_and_b32 v64, 31, v1
    v_lshrrev_b32 v65, 5, v1
    s_lshl_b32 s14, s10, 1
    v_add_u32 v66, s14, v65
    s_lshl_b32 s15, s11, 10
    s_add_u32 s15, s15, 77824
    v_lshl_add_u32 v4, v64, 5, s15
    v_lshl_add_u32 v30, v66, 3, v4
    s_sub_u32 s14, 31, s7
    s_lshl_b32 s14, s14, 8
    v_lshl_add_u32 v84, v64, 3, s14
    v_mov_b32 v83, s72
    s_lshl_b32 s14, s10, 4
    s_lshl_b32 s79, 0xffff, s14
    v_fmac_f32 v34, v12, v32
    v_fmac_f32 v50, v12, v48
    v_fmac_f32 v35, v12, v33
    v_fmac_f32 v51, v12, v49
    v_fmac_f32 v34, v14, v48
    v_fmac_f32 v50, v13, v32
    v_fmac_f32 v35, v14, v49
    v_fmac_f32 v51, v13, v33
    v_fmac_f32 v36, v12, v34
    v_fmac_f32 v52, v12, v50
    v_fmac_f32 v37, v12, v35
    v_fmac_f32 v53, v12, v51
    v_fmac_f32 v36, v14, v50
    v_fmac_f32 v52, v13, v34
    v_fmac_f32 v37, v14, v51
    v_fmac_f32 v53, v13, v35
    v_fmac_f32 v38, v12, v36
    v_fmac_f32 v54, v12, v52
    v_fmac_f32 v39, v12, v37
    v_fmac_f32 v55, v12, v53
    v_fmac_f32 v38, v14, v52
    v_fmac_f32 v54, v13, v36
    v_fmac_f32 v39, v14, v53
    v_fmac_f32 v55, v13, v37
    v_fmac_f32 v40, v12, v38
    v_fmac_f32 v56, v12, v54
    v_fmac_f32 v41, v12, v39
    v_fmac_f32 v57, v12, v55
    v_fmac_f32 v40, v14, v54
    v_fmac_f32 v56, v13, v38
    v_fmac_f32 v41, v14, v55
    v_fmac_f32 v57, v13, v39
    v_fmac_f32 v42, v12, v40
    v_fmac_f32 v58, v12, v56
    v_fmac_f32 v43, v12, v41
    v_fmac_f32 v59, v12, v57
    v_fmac_f32 v42, v14, v56
    v_fmac_f32 v58, v13, v40
    v_fmac_f32 v43, v14, v57
    v_fmac_f32 v59, v13, v41
    v_fmac_f32 v44, v12, v42
    v_fmac_f32 v60, v12, v58
    v_fmac_f32 v45, v12, v43
    v_fmac_f32 v61, v12, v59
    v_fmac_f32 v44, v14, v58
    v_fmac_f32 v60, v13, v42
    v_fmac_f32 v45, v14, v59
    v_fmac_f32 v61, v13, v43
    v_fmac_f32 v46, v12, v44
    v_fmac_f32 v62, v12, v60
    v_fmac_f32 v47, v12, v45
    v_fmac_f32 v63, v12, v61
    v_fmac_f32 v46, v14, v60
    v_fmac_f32 v62, v13, v44
    v_fmac_f32 v47, v14, v61
    v_fmac_f32 v63, v13, v45
    v_fma_f32 v68, v128, v46, v47
    v_fma_f32 v69, v128, v62, v63
    v_fma_f32 v68, -v129, v62, v68
    v_fmac_f32 v69, v129, v46
    ds_write_b64 v30, v[68:69]
    v_mov_b32 v130, v46
    v_mov_b32 v131, v62
    s_waitcnt lgkmcnt(0)
    s_barrier
    ds_read_b128 v[68:71], v4
    ds_read_b128 v[72:75], v4 offset:16
    s_sub_u32 s14, 32, s7
    v_add_u32 v67, s14, v66
    v_lshlrev_b32 v67, 8, v67
    v_lshl_add_u32 v9, v64, 3, v67
    s_add_u32 s14, s7, 3
    v_sub_u32 v10, s14, v66
    v_lshrrev_b32 v10, 2, v10
    s_waitcnt lgkmcnt(1)
    v_fma_f32 v76, v18, v68, v70
    v_fma_f32 v77, v18, v69, v71
    v_fma_f32 v76, -v19, v69, v76
    v_fmac_f32 v77, v19, v68
    s_waitcnt lgkmcnt(0)
    v_fma_f32 v78, v18, v76, v72
    v_fma_f32 v79, v18, v77, v73
    v_fma_f32 v78, -v19, v77, v78
    v_fmac_f32 v79, v19, v76
    v_fma_f32 v80, v18, v78, v74
    v_fma_f32 v81, v18, v79, v75
    v_fma_f32 v80, -v19, v79, v80
    v_fmac_f32 v81, v19, v78
    v_cvt_pk_bf16_f32 v82, v80, v81
    s_mov_b32 exec_lo, s79
    s_mov_b32 exec_hi, 0
    buffer_store_dwordx2 v[82:83], v84, s[64:67], 0 offen sc1
    s_mov_b64 exec, -1
    s_add_u32 m0, s73, 24576
    s_nop 0
    buffer_load_dwordx4 v2, s[52:55], s16 offen lds
    buffer_load_dwordx4 v3, s[52:55], s16 offen offset:1024 lds
    buffer_load_dwordx4 v137, s[56:59], s16 offen offset:2048 lds
    buffer_load_dwordx4 v138, s[56:59], s16 offen offset:3072 lds
    s_add_u32 m0, m0, 4096
    s_nop 0
    buffer_load_dwordx4 v2, s[52:55], s17 offen lds
    buffer_load_dwordx4 v3, s[52:55], s17 offen offset:1024 lds
    s_cmp_eq_u32 s10, 0
    s_cbranch_scc1 B_tw0
    v_cndmask_b32 v26, v76, v78, s[74:75]
    v_cndmask_b32 v27, v77, v79, s[74:75]
    s_branch B_tw1
B_tw0:
    v_cndmask_b32 v26, 0, v68, s[74:75]
    v_cndmask_b32 v27, 0, v69, s[74:75]
B_tw1:
    v_mul_lo_u32 v10, v10, s72
    v_cvt_f32_u32 v104, v66
    v_mul_f32 v105, 0x42800000, v104
    v_mul_f32 v104, 0x41800000, v104
    s_mul_i32 s14, s9, 5120
    s_add_u32 s14, s14, 24576
    v_mul_u32_u24 v67, 80, v64
    v_lshl_add_u32 v67, v65, 5, v67
    v_add_u32 v11, s14, v67
    v_and_b32 v68, 15, v1
    v_lshrrev_b32 v69, 4, v1
    v_lshrrev_b32 v70, 2, v68
    v_lshl_add_u32 v70, v69, 3, v70
    v_mul_u32_u24 v70, 80, v70
    v_and_b32 v71, 3, v68
    v_lshl_add_u32 v70, v71, 3, v70
    v_add_u32 v100, s14, v70
    v_mul_u32_u24 v103, 7168, v69
    v_lshl_add_u32 v103, v68, 2, v103
    v_bfe_u32 v70, v68, 1, 3
    v_xor_b32 v70, v70, v69
    v_lshlrev_b32 v70, 4, v70
    v_lshl_add_u32 v70, v68, 7, v70
    s_mul_i32 s14, s9, 6144
    v_add_u32 v5, s14, v70
    v_xor_b32 v6, 64, v5
    v_lshlrev_b32 v101, 4, v1
    v_mul_f32 v106, 0x43800000, v142
    v_mul_f32 v108, v105, v142
    v_mul_f32 v110, v104, v142
    v_mul_f32 v107, 0x43800000, v143
    v_mul_f32 v109, v105, v143
    v_mul_f32 v111, v104, v143
    v_exp_f32 v106, v106
    v_exp_f32 v108, v108
    v_exp_f32 v110, v110
    v_fract_f32 v107, v107
    v_fract_f32 v109, v109
    v_fract_f32 v111, v111
    v_cos_f32 v24, v107
    v_cos_f32 v22, v109
    v_cos_f32 v20, v111
    v_sin_f32 v25, v107
    v_sin_f32 v23, v109
    v_sin_f32 v21, v111
    v_mul_f32 v24, v24, v106
    v_mul_f32 v22, v22, v108
    v_mul_f32 v20, v20, v110
    v_mul_f32 v25, v25, v106
    v_mul_f32 v23, v23, v108
    v_mul_f32 v21, v21, v110
    s_movk_i32 s15, 4096
    v_mul_f32 v104, v140, v140
    s_add_u32 m0, s73, 49152
    s_nop 0
    buffer_load_dwordx4 v2, s[56:59], s17 offen lds
    v_fmac_f32 v104, v141, v141
    v_add_f32 v105, -1.0, v12
    v_rcp_f32 v104, v104
    v_mul_f32 v106, v105, v140
    v_mul_f32 v107, v13, v140
    v_fmac_f32 v106, v13, v141
    v_add_f32 v104, v104, v104
    v_fma_f32 v107, -v105, v141, v107
    v_mul_f32 v16, v106, v104
    buffer_load_dwordx4 v3, s[56:59], s17 offen offset:1024 lds
    v_mul_f32 v17, v107, v104
    v_mul_f32 v104, v17, v32
    v_mul_f32 v32, v16, v32
    v_mul_f32 v112, v12, v16
    v_mul_f32 v105, v17, v33
    v_mul_f32 v33, v16, v33
    v_mul_f32 v113, v12, v17
    v_fma_f32 v32, -v17, v48, v32
    v_fma_f32 v48, v16, v48, v104
    buffer_load_dwordx4 v137, s[52:55], s18 offen offset:2048 lds
    v_fma_f32 v112, -v13, v17, v112
    v_fma_f32 v33, -v17, v49, v33
    v_fma_f32 v49, v16, v49, v105
    v_fmac_f32 v113, v13, v16
    v_mul_f32 v104, v17, v34
    v_mul_f32 v34, v16, v34
    v_mul_f32 v114, v12, v112
    v_mul_f32 v105, v17, v35
    v_mul_f32 v35, v16, v35
    buffer_load_dwordx4 v138, s[52:55], s18 offen offset:3072 lds
    v_mul_f32 v115, v12, v113
    v_fma_f32 v34, -v17, v50, v34
    v_fma_f32 v50, v16, v50, v104
    v_fma_f32 v114, -v13, v113, v114
    v_fma_f32 v35, -v17, v51, v35
    v_fma_f32 v51, v16, v51, v105
    v_fmac_f32 v115, v13, v112
    v_mul_f32 v104, v17, v36
    v_mul_f32 v36, v16, v36
    s_add_u32 m0, m0, 4096
    s_nop 0
    buffer_load_dwordx4 v2, s[56:59], s18 offen lds
    v_mul_f32 v116, v12, v114
    v_mul_f32 v105, v17, v37
    v_mul_f32 v37, v16, v37
    v_mul_f32 v117, v12, v115
    v_fma_f32 v36, -v17, v52, v36
    v_fma_f32 v52, v16, v52, v104
    v_fma_f32 v116, -v13, v115, v116
    v_fma_f32 v37, -v17, v53, v37
    v_fma_f32 v53, v16, v53, v105
    buffer_load_dwordx4 v3, s[56:59], s18 offen offset:1024 lds
    v_fmac_f32 v117, v13, v114
    v_mul_f32 v104, v17, v38
    v_mul_f32 v38, v16, v38
    v_mul_f32 v118, v12, v116
    v_mul_f32 v105, v17, v39
    v_mul_f32 v39, v16, v39
    v_mul_f32 v119, v12, v117
    v_fma_f32 v38, -v17, v54, v38
    v_fma_f32 v54, v16, v54, v104
    s_add_u32 m0, s73, 0
    s_nop 0
    buffer_load_dwordx4 v2, s[52:55], s19 offen lds
    v_fma_f32 v118, -v13, v117, v118
    v_fma_f32 v39, -v17, v55, v39
    v_fma_f32 v55, v16, v55, v105
    v_fmac_f32 v119, v13, v116
    v_mul_f32 v104, v17, v40
    v_mul_f32 v40, v16, v40
    v_mul_f32 v120, v12, v118
    v_mul_f32 v105, v17, v41
    v_mul_f32 v41, v16, v41
    buffer_load_dwordx4 v3, s[52:55], s19 offen offset:1024 lds
    v_mul_f32 v121, v12, v119
    v_fma_f32 v40, -v17, v56, v40
    v_fma_f32 v56, v16, v56, v104
    v_fma_f32 v120, -v13, v119, v120
    v_fma_f32 v41, -v17, v57, v41
    v_fma_f32 v57, v16, v57, v105
    v_fmac_f32 v121, v13, v118
    v_mul_f32 v104, v17, v42
    v_mul_f32 v42, v16, v42
    buffer_load_dwordx4 v137, s[56:59], s19 offen offset:2048 lds
    v_mul_f32 v122, v12, v120
    v_mul_f32 v105, v17, v43
    v_mul_f32 v43, v16, v43
    v_mul_f32 v123, v12, v121
    v_fma_f32 v42, -v17, v58, v42
    v_fma_f32 v58, v16, v58, v104
    v_fma_f32 v122, -v13, v121, v122
    v_fma_f32 v43, -v17, v59, v43
    v_fma_f32 v59, v16, v59, v105
    buffer_load_dwordx4 v138, s[56:59], s19 offen offset:3072 lds
    v_fmac_f32 v123, v13, v120
    v_mul_f32 v104, v17, v44
    v_mul_f32 v44, v16, v44
    v_mul_f32 v124, v12, v122
    v_mul_f32 v105, v17, v45
    v_mul_f32 v45, v16, v45
    v_mul_f32 v125, v12, v123
    v_fma_f32 v44, -v17, v60, v44
    v_fma_f32 v60, v16, v60, v104
    s_add_u32 m0, m0, 4096
    s_nop 0
    buffer_load_dwordx4 v2, s[52:55], s20 offen lds
    v_fma_f32 v124, -v13, v123, v124
    v_fma_f32 v45, -v17, v61, v45
    v_fma_f32 v61, v16, v61, v105
    v_fmac_f32 v125, v13, v122
    v_mul_f32 v104, v17, v46
    v_mul_f32 v46, v16, v46
    v_mul_f32 v126, v12, v124
    v_mul_f32 v105, v17, v47
    v_mul_f32 v47, v16, v47
    buffer_load_dwordx4 v3, s[52:55], s20 offen offset:1024 lds
    v_mul_f32 v127, v12, v125
    v_fma_f32 v46, -v17, v62, v46
    v_fma_f32 v62, v16, v62, v104
    v_fma_f32 v126, -v13, v125, v126
    v_fma_f32 v47, -v17, v63, v47
    v_fma_f32 v63, v16, v63, v105
    v_fmac_f32 v127, v13, v124
    v_mul_f32 v84, v240, v28
    v_mul_f32 v85, v241, v28
    v_mul_f32 v86, v242, v28
    v_mul_f32 v87, v243, v28
    v_mul_f32 v88, v244, v28
    v_mul_f32 v89, v245, v28
    v_mul_f32 v90, v246, v28
    v_mul_f32 v91, v247, v28
    v_mul_f32 v92, v248, v28
    v_mul_f32 v93, v249, v28
    v_mul_f32 v94, v250, v28
    v_mul_f32 v95, v251, v28
    v_mul_f32 v96, v252, v28
    v_mul_f32 v97, v253, v28
    v_mul_f32 v98, v254, v28
    v_mul_f32 v99, v255, v28
    s_waitcnt vmcnt(12)
    ds_read_b128 v[144:147], v5 offset:24576
    ds_read_b128 v[148:151], v6 offset:24576
    ds_read_b128 v[152:155], v5 offset:26624
    ds_read_b128 v[156:159], v6 offset:26624
    ds_read_b128 v[160:163], v5 offset:28672
    ds_read_b128 v[164:167], v6 offset:28672
    buffer_load_dwordx2 v[64:65], v9, s[64:67], 0 offen offset:0 sc1
    buffer_load_dwordx2 v[66:67], v9, s[64:67], 0 offen offset:1024 sc1
    buffer_load_dwordx2 v[68:69], v9, s[64:67], 0 offen offset:2048 sc1
    buffer_load_dwordx2 v[70:71], v9, s[64:67], 0 offen offset:3072 sc1
    buffer_load_dwordx2 v[72:73], v9, s[64:67], s15 offen offset:0 sc1
    buffer_load_dwordx2 v[74:75], v9, s[64:67], s15 offen offset:1024 sc1
    buffer_load_dwordx2 v[76:77], v9, s[64:67], s15 offen offset:2048 sc1
    buffer_load_dwordx2 v[78:79], v9, s[64:67], s15 offen offset:3072 sc1
    s_waitcnt vmcnt(8)
    ds_read_b128 v[168:171], v5 offset:49152
    ds_read_b128 v[172:175], v6 offset:49152
    ds_read_b128 v[176:179], v5 offset:51200
    ds_read_b128 v[180:183], v6 offset:51200
    ds_read_b128 v[184:187], v5 offset:53248
    ds_read_b128 v[188:191], v6 offset:53248
    ds_read_b128 v[192:195], v5 offset:0
    ds_read_b128 v[196:199], v6 offset:0
    ds_read_b128 v[200:203], v5 offset:2048
    ds_read_b128 v[204:207], v6 offset:2048
    ds_read_b128 v[208:211], v5 offset:4096
    ds_read_b128 v[212:215], v6 offset:4096
    s_waitcnt lgkmcnt(0)
    s_add_u32 m0, s73, 0
    s_nop 0
    buffer_load_dwordx4 v2, s[56:59], s20 offen lds
    buffer_load_dwordx4 v3, s[56:59], s20 offen offset:1024 lds
    buffer_load_dwordx4 v137, s[52:55], s21 offen offset:2048 lds
    buffer_load_dwordx4 v138, s[52:55], s21 offen offset:3072 lds
    s_add_u32 m0, m0, 4096
    s_nop 0
    buffer_load_dwordx4 v2, s[56:59], s21 offen lds
    buffer_load_dwordx4 v3, s[56:59], s21 offen offset:1024 lds
    s_add_u32 m0, s73, 49152
    s_nop 0
    buffer_load_dwordx4 v2, s[52:55], s22 offen lds
    buffer_load_dwordx4 v3, s[52:55], s22 offen offset:1024 lds
    buffer_load_dwordx4 v137, s[56:59], s22 offen offset:2048 lds
    buffer_load_dwordx4 v138, s[56:59], s22 offen offset:3072 lds
    s_waitcnt vmcnt(10)
B_lb:
    v_add3_u32 v82, v65, v67, v69
    v_add3_u32 v83, v71, v73, v75
    v_add3_u32 v82, v82, v77, v79
    v_add_u32 v82, v82, v83
    v_cmp_eq_u32 vcc, v82, v10
    s_cmp_eq_u64 vcc, -1
    s_cbranch_scc1 B_lb_ok
    s_sub_u32 s98, s98, 1
    s_cbranch_scc1 L_exit
    s_sleep 1
    buffer_load_dwordx2 v[64:65], v9, s[64:67], 0 offen offset:0 sc1
    buffer_load_dwordx2 v[66:67], v9, s[64:67], 0 offen offset:1024 sc1
    buffer_load_dwordx2 v[68:69], v9, s[64:67], 0 offen offset:2048 sc1
    buffer_load_dwordx2 v[70:71], v9, s[64:67], 0 offen offset:3072 sc1
    buffer_load_dwordx2 v[72:73], v9, s[64:67], s15 offen offset:0 sc1
    buffer_load_dwordx2 v[74:75], v9, s[64:67], s15 offen offset:1024 sc1
    buffer_load_dwordx2 v[76:77], v9, s[64:67], s15 offen offset:2048 sc1
    buffer_load_dwordx2 v[78:79], v9, s[64:67], s15 offen offset:3072 sc1
    s_waitcnt vmcnt(0)
    s_branch B_lb
B_lb_ok:
    s_setprio 3
    v_and_b32 v79, 0xffff0000, v78
    v_lshlrev_b32 v78, 16, v78
    v_and_b32 v77, 0xffff0000, v76
    v_lshlrev_b32 v76, 16, v76
    v_and_b32 v75, 0xffff0000, v74
    v_lshlrev_b32 v74, 16, v74
    v_fmac_f32 v76, v24, v78
    v_fmac_f32 v77, v24, v79
    v_fma_f32 v76, -v25, v79, v76
    v_fmac_f32 v77, v25, v78
    v_and_b32 v73, 0xffff0000, v72
    v_lshlrev_b32 v72, 16, v72
    v_fmac_f32 v74, v24, v76
    v_fmac_f32 v75, v24, v77
    v_fma_f32 v74, -v25, v77, v74
    v_fmac_f32 v75, v25, v76
    v_and_b32 v71, 0xffff0000, v70
    v_lshlrev_b32 v70, 16, v70
    v_fmac_f32 v72, v24, v74
    v_fmac_f32 v73, v24, v75
    v_fma_f32 v72, -v25, v75, v72
    v_fmac_f32 v73, v25, v74
    v_and_b32 v69, 0xffff0000, v68
    v_lshlrev_b32 v68, 16, v68
    v_fmac_f32 v70, v24, v72
    v_fmac_f32 v71, v24, v73
    v_fma_f32 v70, -v25, v73, v70
    v_fmac_f32 v71, v25, v72
    v_and_b32 v67, 0xffff0000, v66
    v_lshlrev_b32 v66, 16, v66
    v_fmac_f32 v68, v24, v70
    v_fmac_f32 v69, v24, v71
    v_fma_f32 v68, -v25, v71, v68
    v_fmac_f32 v69, v25, v70
    v_and_b32 v65, 0xffff0000, v64
    v_lshlrev_b32 v64, 16, v64
    v_fmac_f32 v66, v24, v68
    v_fmac_f32 v67, v24, v69
    v_fma_f32 v66, -v25, v69, v66
    v_fmac_f32 v67, v25, v68
    v_fmac_f32 v64, v24, v66
    v_fmac_f32 v65, v24, v67
    v_fma_f32 v64, -v25, v67, v64
    v_fmac_f32 v65, v25, v66
    v_mul_f32 v80, v22, v64
    v_mul_f32 v81, v22, v65
    v_fma_f32 v80, -v23, v65, v80
    v_fmac_f32 v81, v23, v64
    ds_write_b64 v30, v[80:81] offset:2048
    s_waitcnt lgkmcnt(0)
    s_barrier
    ds_read_b128 v[68:71], v4 offset:2048
    ds_read_b128 v[72:75], v4 offset:2064
    s_lshl_b32 s15, s11, 12
    s_lshl_b32 s14, s10, 11
    s_add_u32 s14, s14, s15
    s_mul_i32 s15, s9, 5120
    s_add_u32 s15, s15, 24576
    v_add_u32 v139, s15, v101
    s_lshl_b32 s15, s6, 14
    s_add_u32 s14, s14, s15
    s_add_u32 s15, s14, 8192
    s_waitcnt lgkmcnt(0)
    v_add_f32 v68, v68, v70
    v_add_f32 v69, v69, v71
    v_add_f32 v72, v72, v74
    v_add_f32 v73, v73, v75
    v_add_f32 v68, v68, v72
    v_add_f32 v69, v69, v73
    v_fmac_f32 v26, v20, v68
    v_fmac_f32 v27, v20, v69
    v_fma_f32 v26, -v21, v69, v26
    v_fmac_f32 v27, v21, v68
    v_fma_f32 v133, v128, v26, v130
    v_fma_f32 v135, v128, v27, v131
    v_mov_b32 v132, v26
    v_mov_b32 v134, v27
    v_fma_f32 v133, -v129, v27, v133
    v_fmac_f32 v135, v129, v26
    v_fmac_f32 v32, v112, v132
    v_fmac_f32 v48, v112, v134
    v_fmac_f32 v33, v112, v133
    v_fmac_f32 v49, v112, v135
    v_fma_f32 v32, -v113, v134, v32
    v_fmac_f32 v48, v113, v132
    v_fma_f32 v33, -v113, v135, v33
    v_fmac_f32 v49, v113, v133
    v_cvt_pk_bf16_f32 v64, v32, v33
    v_cvt_pk_bf16_f32 v72, -v48, -v49
    v_fmac_f32 v34, v114, v132
    v_fmac_f32 v50, v114, v134
    v_fmac_f32 v35, v114, v133
    v_fmac_f32 v51, v114, v135
    v_fma_f32 v34, -v115, v134, v34
    v_fmac_f32 v50, v115, v132
    v_fma_f32 v35, -v115, v135, v35
    v_fmac_f32 v51, v115, v133
    v_cvt_pk_bf16_f32 v65, v34, v35
    v_cvt_pk_bf16_f32 v73, -v50, -v51
    v_fmac_f32 v36, v116, v132
    v_fmac_f32 v52, v116, v134
    v_fmac_f32 v37, v116, v133
    v_fmac_f32 v53, v116, v135
    v_fma_f32 v36, -v117, v134, v36
    v_fmac_f32 v52, v117, v132
    v_fma_f32 v37, -v117, v135, v37
    v_fmac_f32 v53, v117, v133
    v_cvt_pk_bf16_f32 v66, v36, v37
    v_cvt_pk_bf16_f32 v74, -v52, -v53
    v_fmac_f32 v38, v118, v132
    v_fmac_f32 v54, v118, v134
    v_fmac_f32 v39, v118, v133
    v_fmac_f32 v55, v118, v135
    v_fma_f32 v38, -v119, v134, v38
    v_fmac_f32 v54, v119, v132
    v_fma_f32 v39, -v119, v135, v39
    v_fmac_f32 v55, v119, v133
    v_cvt_pk_bf16_f32 v67, v38, v39
    v_cvt_pk_bf16_f32 v75, -v54, -v55
    ds_write_b128 v11, v[64:67] offset:0
    ds_write_b128 v11, v[72:75] offset:2560
    v_fmac_f32 v40, v120, v132
    v_fmac_f32 v56, v120, v134
    v_fmac_f32 v41, v120, v133
    v_fmac_f32 v57, v120, v135
    v_fma_f32 v40, -v121, v134, v40
    v_fmac_f32 v56, v121, v132
    v_fma_f32 v41, -v121, v135, v41
    v_fmac_f32 v57, v121, v133
    v_cvt_pk_bf16_f32 v68, v40, v41
    v_cvt_pk_bf16_f32 v76, -v56, -v57
    v_fmac_f32 v42, v122, v132
    v_fmac_f32 v58, v122, v134
    v_fmac_f32 v43, v122, v133
    v_fmac_f32 v59, v122, v135
    v_fma_f32 v42, -v123, v134, v42
    v_fmac_f32 v58, v123, v132
    v_fma_f32 v43, -v123, v135, v43
    v_fmac_f32 v59, v123, v133
    v_cvt_pk_bf16_f32 v69, v42, v43
    v_cvt_pk_bf16_f32 v77, -v58, -v59
    v_fmac_f32 v44, v124, v132
    v_fmac_f32 v60, v124, v134
    v_fmac_f32 v45, v124, v133
    v_fmac_f32 v61, v124, v135
    v_fma_f32 v44, -v125, v134, v44
    v_fmac_f32 v60, v125, v132
    v_fma_f32 v45, -v125, v135, v45
    v_fmac_f32 v61, v125, v133
    v_cvt_pk_bf16_f32 v70, v44, v45
    v_cvt_pk_bf16_f32 v78, -v60, -v61
    v_fmac_f32 v46, v126, v132
    v_fmac_f32 v62, v126, v134
    v_fmac_f32 v47, v126, v133
    v_fmac_f32 v63, v126, v135
    v_fma_f32 v46, -v127, v134, v46
    v_fmac_f32 v62, v127, v132
    v_fma_f32 v47, -v127, v135, v47
    v_fmac_f32 v63, v127, v133
    v_cvt_pk_bf16_f32 v71, v46, v47
    v_cvt_pk_bf16_f32 v79, -v62, -v63
    ds_write_b128 v11, v[68:71] offset:16
    ds_write_b128 v11, v[76:79] offset:2576
    ds_read_b64_tr_b16 v[32:33], v100 offset:0
    ds_read_b64_tr_b16 v[34:35], v100 offset:320
    ds_read_b64_tr_b16 v[36:37], v100 offset:32
    ds_read_b64_tr_b16 v[38:39], v100 offset:352
    ds_read_b64_tr_b16 v[40:41], v100 offset:2560
    ds_read_b64_tr_b16 v[42:43], v100 offset:2880
    ds_read_b64_tr_b16 v[44:45], v100 offset:2592
    ds_read_b64_tr_b16 v[46:47], v100 offset:2912
    s_waitcnt lgkmcnt(6)
    buffer_store_dwordx4 v[32:35], v101, s[68:71], s14 offen offset:0 nt
    s_waitcnt lgkmcnt(4)
    buffer_store_dwordx4 v[36:39], v101, s[68:71], s14 offen offset:1024 nt
    s_waitcnt lgkmcnt(2)
    buffer_store_dwordx4 v[40:43], v101, s[68:71], s15 offen offset:0 nt
    s_waitcnt lgkmcnt(0)
    buffer_store_dwordx4 v[44:47], v101, s[68:71], s15 offen offset:1024 nt
    ds_write_b128 v139, v[32:35] offset:0
    ds_write_b128 v139, v[36:39] offset:1024
    ds_write_b128 v139, v[40:43] offset:2048
    ds_write_b128 v139, v[44:47] offset:3072
    s_mov_b32 s82, s14
    s_mov_b32 s83, s15
    s_lshl_b32 s14, s7, 9
    s_add_u32 s14, s14, 0x1000
    v_min_u32 v64, 6, v1
    v_lshl_add_u32 v64, v64, 6, s14
    v_mov_b32 v66, s72
    v_mov_b32 v67, s77
    v_mov_b32 v65, 77824
    v_add_u32 v136, 32768, v101
    s_waitcnt vmcnt(0) lgkmcnt(0)
    s_barrier
    s_cmp_lg_u32 s9, 0
    s_cbranch_scc1 B_noflag
    s_lshl_b32 s15, 1, s6
    s_mov_b32 exec_lo, s15
    s_mov_b32 exec_hi, 0
    global_store_dwordx2 v64, v[66:67], s[38:39]
    s_mov_b64 exec, -1
    global_load_dwordx2 v[66:67], v64, s[38:39] sc1
B_noflag:
    s_lshl_b32 s73, s9, 12
    ds_read_b128 v[32:35], v101 offset:24576
    ds_read_b128 v[36:39], v101 offset:25600
    ds_read_b128 v[40:43], v101 offset:29696
    ds_read_b128 v[44:47], v101 offset:30720
    ds_read_b128 v[48:51], v136 offset:2048
    ds_read_b128 v[52:55], v136 offset:3072
    ds_read_b128 v[56:59], v136 offset:7168
    ds_read_b128 v[60:63], v136 offset:8192
    ds_read_b128 v[104:107], v101 offset:26624
    ds_read_b128 v[108:111], v101 offset:27648
    ds_read_b128 v[112:115], v101 offset:31744
    ds_read_b128 v[116:119], v136 offset:0
    s_waitcnt lgkmcnt(8)
    v_mfma_f32_16x16x32_bf16 v[84:87], v[32:35], v[144:147], v[84:87]
    v_mfma_f32_16x16x32_bf16 v[88:91], v[36:39], v[144:147], v[88:91]
    v_mfma_f32_16x16x32_bf16 v[92:95], v[40:43], v[144:147], v[92:95]
    v_mfma_f32_16x16x32_bf16 v[96:99], v[44:47], v[144:147], v[96:99]
    ds_read_b128 v[120:123], v136 offset:4096
    ds_read_b128 v[124:127], v136 offset:5120
    ds_read_b128 v[128:131], v136 offset:9216
    ds_read_b128 v[132:135], v136 offset:10240
    s_waitcnt lgkmcnt(8)
    v_mfma_f32_16x16x32_bf16 v[84:87], v[48:51], v[148:151], v[84:87]
    v_mfma_f32_16x16x32_bf16 v[88:91], v[52:55], v[148:151], v[88:91]
    v_mfma_f32_16x16x32_bf16 v[92:95], v[56:59], v[148:151], v[92:95]
    v_mfma_f32_16x16x32_bf16 v[96:99], v[60:63], v[148:151], v[96:99]
    s_waitcnt lgkmcnt(4)
    v_mfma_f32_16x16x32_bf16 v[84:87], v[104:107], v[152:155], v[84:87]
    v_mfma_f32_16x16x32_bf16 v[88:91], v[108:111], v[152:155], v[88:91]
    v_mfma_f32_16x16x32_bf16 v[92:95], v[112:115], v[152:155], v[92:95]
    v_mfma_f32_16x16x32_bf16 v[96:99], v[116:119], v[152:155], v[96:99]
    s_waitcnt lgkmcnt(0)
    v_mfma_f32_16x16x32_bf16 v[84:87], v[120:123], v[156:159], v[84:87]
    v_mfma_f32_16x16x32_bf16 v[88:91], v[124:127], v[156:159], v[88:91]
    v_mfma_f32_16x16x32_bf16 v[92:95], v[128:131], v[156:159], v[92:95]
    v_mfma_f32_16x16x32_bf16 v[96:99], v[132:135], v[156:159], v[96:99]
    ds_read_b128 v[216:219], v5 offset:0
    ds_read_b128 v[220:223], v6 offset:0
    ds_read_b128 v[224:227], v5 offset:2048
    ds_read_b128 v[228:231], v6 offset:2048
    ds_read_b128 v[232:235], v5 offset:4096
    ds_read_b128 v[236:239], v6 offset:4096
    ds_read_b128 v[240:243], v5 offset:49152
    ds_read_b128 v[244:247], v6 offset:49152
    ds_read_b128 v[248:251], v5 offset:51200
    ds_read_b128 v[252:255], v6 offset:51200
    s_cmp_lg_u32 s9, 0
    s_cbranch_scc1 B_h_b
    s_mov_b32 s78, 60
    s_branch B_h_p1
B_h_p:
    s_sub_u32 s78, s78, 1
    s_cbranch_scc1 B_h_t
    global_load_dwordx2 v[66:67], v64, s[38:39] sc1
B_h_p1:
    s_waitcnt vmcnt(0)
    v_cmp_ne_u32 vcc, s72, v66
    v_cmp_ne_u32 s[92:93], s77, v67
    s_or_b64 vcc, vcc, s[92:93]
    s_and_b64 exec, exec, vcc
    s_cbranch_execnz B_h_p
    s_mov_b32 s78, 0
B_h_t:
    s_mov_b64 exec, -1
    s_add_u32 s78, s78, 1
    v_mov_b32 v68, s78
    ds_write_b32 v65, v68
B_h_b:
    s_waitcnt lgkmcnt(0)
    s_barrier
    ds_read_b32 v68, v65
    s_waitcnt lgkmcnt(0)
    v_readfirstlane_b32 s78, v68
    s_cmp_lg_u32 s78, 0
    s_cbranch_scc1 B_h_ok
    ds_read_b128 v[32:35], v139 offset:0
    ds_read_b128 v[36:39], v139 offset:1024
    ds_read_b128 v[40:43], v139 offset:2048
    ds_read_b128 v[44:47], v139 offset:3072
    s_waitcnt lgkmcnt(0)
    buffer_store_dwordx4 v[32:35], v101, s[68:71], s82 offen offset:0 sc1
    buffer_store_dwordx4 v[36:39], v101, s[68:71], s82 offen offset:1024 sc1
    buffer_store_dwordx4 v[40:43], v101, s[68:71], s83 offen offset:0 sc1
    buffer_store_dwordx4 v[44:47], v101, s[68:71], s83 offen offset:1024 sc1
    s_waitcnt vmcnt(0)
    s_barrier
    s_cmp_lg_u32 s9, 0
    s_cbranch_scc1 B_h_c
    v_add_u32 v69, 16384, v64
    s_lshl_b32 s92, 1, s6
    v_mov_b32 v68, s72
    s_mov_b32 exec_lo, s92
    s_mov_b32 exec_hi, 0
    global_store_dword v69, v68, s[38:39] sc1
    s_mov_b64 exec, -1
B_h_q:
    s_sub_u32 s98, s98, 1
    s_cbranch_scc1 L_exit
    global_load_dwordx2 v[66:67], v64, s[38:39] sc1
    global_load_dword v68, v69, s[38:39] sc1
    s_waitcnt vmcnt(0)
    v_cmp_eq_u32 vcc, s72, v68
    s_cmp_eq_u64 vcc, -1
    s_cbranch_scc1 B_h_d
    v_cmp_eq_u32 vcc, s72, v66
    v_cmp_eq_u32 s[92:93], s77, v67
    s_and_b64 vcc, vcc, s[92:93]
    s_cmp_eq_u64 vcc, -1
    s_cbranch_scc0 B_h_q
    s_mov_b32 s78, 1
B_h_d:
    v_mov_b32 v68, s78
    ds_write_b32 v65, v68
B_h_c:
    s_waitcnt lgkmcnt(0)
    s_barrier
    ds_read_b32 v68, v65
    s_waitcnt lgkmcnt(0)
    v_readfirstlane_b32 s78, v68
B_h_ok:
    s_add_u32 m0, s73, 0
    s_add_u32 s79, s24, s73
    buffer_load_dwordx4 v101, s[68:71], s79 offen sc1 lds
    buffer_load_dwordx4 v101, s[68:71], s79 offen offset:1024 sc1 lds
    buffer_load_dwordx4 v101, s[68:71], s79 offen offset:2048 sc1 lds
    buffer_load_dwordx4 v101, s[68:71], s79 offen offset:3072 sc1 lds
    s_add_u32 m0, s73, 16384
    s_add_u32 s79, s25, s73
    buffer_load_dwordx4 v101, s[68:71], s79 offen sc1 lds
    buffer_load_dwordx4 v101, s[68:71], s79 offen offset:1024 sc1 lds
    buffer_load_dwordx4 v101, s[68:71], s79 offen offset:2048 sc1 lds
    buffer_load_dwordx4 v101, s[68:71], s79 offen offset:3072 sc1 lds
    s_add_u32 m0, s73, 32768
    s_add_u32 s79, s26, s73
    buffer_load_dwordx4 v101, s[68:71], s79 offen sc1 lds
    buffer_load_dwordx4 v101, s[68:71], s79 offen offset:1024 sc1 lds
    buffer_load_dwordx4 v101, s[68:71], s79 offen offset:2048 sc1 lds
    buffer_load_dwordx4 v101, s[68:71], s79 offen offset:3072 sc1 lds
    s_waitcnt vmcnt(8)
    s_barrier
    ds_read_b128 v[32:35], v101 offset:0
    ds_read_b128 v[36:39], v101 offset:1024
    ds_read_b128 v[40:43], v101 offset:2048
    ds_read_b128 v[44:47], v101 offset:3072
    ds_read_b128 v[48:51], v101 offset:4096
    ds_read_b128 v[52:55], v101 offset:5120
    ds_read_b128 v[56:59], v101 offset:6144
    ds_read_b128 v[60:63], v101 offset:7168
    s_waitcnt lgkmcnt(4)
    v_mfma_f32_16x16x32_bf16 v[84:87], v[32:35], v[160:163], v[84:87]
    ds_read_b128 v[104:107], v101 offset:8192
    s_add_u32 m0, s73, 49152
    s_add_u32 s79, s27, s73
    buffer_load_dwordx4 v101, s[68:71], s79 offen sc1 lds
    v_mfma_f32_16x16x32_bf16 v[88:91], v[36:39], v[160:163], v[88:91]
    ds_read_b128 v[108:111], v101 offset:9216
    buffer_load_dwordx4 v101, s[68:71], s79 offen offset:1024 sc1 lds
    v_mfma_f32_16x16x32_bf16 v[92:95], v[40:43], v[160:163], v[92:95]
    ds_read_b128 v[112:115], v101 offset:10240
    buffer_load_dwordx4 v101, s[68:71], s79 offen offset:2048 sc1 lds
    v_mfma_f32_16x16x32_bf16 v[96:99], v[44:47], v[160:163], v[96:99]
    ds_read_b128 v[116:119], v101 offset:11264
    buffer_load_dwordx4 v101, s[68:71], s79 offen offset:3072 sc1 lds
    s_waitcnt lgkmcnt(4)
    v_mfma_f32_16x16x32_bf16 v[84:87], v[48:51], v[164:167], v[84:87]
    ds_read_b128 v[120:123], v101 offset:12288
    v_mfma_f32_16x16x32_bf16 v[88:91], v[52:55], v[164:167], v[88:91]
    ds_read_b128 v[124:127], v101 offset:13312
    v_mfma_f32_16x16x32_bf16 v[92:95], v[56:59], v[164:167], v[92:95]
    ds_read_b128 v[128:131], v101 offset:14336
    v_mfma_f32_16x16x32_bf16 v[96:99], v[60:63], v[164:167], v[96:99]
    ds_read_b128 v[132:135], v101 offset:15360
    s_waitcnt lgkmcnt(4)
    v_mfma_f32_16x16x32_bf16 v[84:87], v[104:107], v[168:171], v[84:87]
    v_mfma_f32_16x16x32_bf16 v[88:91], v[108:111], v[168:171], v[88:91]
    s_waitcnt vmcnt(8) lgkmcnt(0)
    s_barrier
    v_mfma_f32_16x16x32_bf16 v[92:95], v[112:115], v[168:171], v[92:95]
    ds_read_b128 v[32:35], v101 offset:16384
    s_add_u32 m0, s73, 0
    s_add_u32 s79, s28, s73
    buffer_load_dwordx4 v101, s[68:71], s79 offen sc1 lds
    v_mfma_f32_16x16x32_bf16 v[96:99], v[116:119], v[168:171], v[96:99]
    ds_read_b128 v[36:39], v101 offset:17408
    buffer_load_dwordx4 v101, s[68:71], s79 offen offset:1024 sc1 lds
    v_mfma_f32_16x16x32_bf16 v[84:87], v[120:123], v[172:175], v[84:87]
    ds_read_b128 v[40:43], v101 offset:18432
    buffer_load_dwordx4 v101, s[68:71], s79 offen offset:2048 sc1 lds
    v_mfma_f32_16x16x32_bf16 v[88:91], v[124:127], v[172:175], v[88:91]
    ds_read_b128 v[44:47], v101 offset:19456
    buffer_load_dwordx4 v101, s[68:71], s79 offen offset:3072 sc1 lds
    v_mfma_f32_16x16x32_bf16 v[92:95], v[128:131], v[172:175], v[92:95]
    ds_read_b128 v[48:51], v101 offset:20480
    v_mfma_f32_16x16x32_bf16 v[96:99], v[132:135], v[172:175], v[96:99]
    ds_read_b128 v[52:55], v101 offset:21504
    ds_read_b128 v[56:59], v101 offset:22528
    ds_read_b128 v[60:63], v101 offset:23552
    s_waitcnt lgkmcnt(4)
    v_mfma_f32_16x16x32_bf16 v[84:87], v[32:35], v[176:179], v[84:87]
    ds_read_b128 v[104:107], v101 offset:24576
    v_mfma_f32_16x16x32_bf16 v[88:91], v[36:39], v[176:179], v[88:91]
    ds_read_b128 v[108:111], v101 offset:25600
    v_mfma_f32_16x16x32_bf16 v[92:95], v[40:43], v[176:179], v[92:95]
    ds_read_b128 v[112:115], v101 offset:26624
    v_mfma_f32_16x16x32_bf16 v[96:99], v[44:47], v[176:179], v[96:99]
    ds_read_b128 v[116:119], v101 offset:27648
    s_waitcnt lgkmcnt(4)
    v_mfma_f32_16x16x32_bf16 v[84:87], v[48:51], v[180:183], v[84:87]
    ds_read_b128 v[120:123], v101 offset:28672
    v_mfma_f32_16x16x32_bf16 v[88:91], v[52:55], v[180:183], v[88:91]
    ds_read_b128 v[124:127], v101 offset:29696
    v_mfma_f32_16x16x32_bf16 v[92:95], v[56:59], v[180:183], v[92:95]
    ds_read_b128 v[128:131], v101 offset:30720
    v_mfma_f32_16x16x32_bf16 v[96:99], v[60:63], v[180:183], v[96:99]
    ds_read_b128 v[132:135], v101 offset:31744
    s_waitcnt lgkmcnt(4)
    v_mfma_f32_16x16x32_bf16 v[84:87], v[104:107], v[184:187], v[84:87]
    v_mfma_f32_16x16x32_bf16 v[88:91], v[108:111], v[184:187], v[88:91]
    s_waitcnt vmcnt(8) lgkmcnt(0)
    s_barrier
    v_mfma_f32_16x16x32_bf16 v[92:95], v[112:115], v[184:187], v[92:95]
    ds_read_b128 v[32:35], v136 offset:0
    s_add_u32 m0, s73, 16384
    s_add_u32 s79, s29, s73
    buffer_load_dwordx4 v101, s[68:71], s79 offen sc1 lds
    v_mfma_f32_16x16x32_bf16 v[96:99], v[116:119], v[184:187], v[96:99]
    ds_read_b128 v[36:39], v136 offset:1024
    buffer_load_dwordx4 v101, s[68:71], s79 offen offset:1024 sc1 lds
    v_mfma_f32_16x16x32_bf16 v[84:87], v[120:123], v[188:191], v[84:87]
    ds_read_b128 v[40:43], v136 offset:2048
    buffer_load_dwordx4 v101, s[68:71], s79 offen offset:2048 sc1 lds
    v_mfma_f32_16x16x32_bf16 v[88:91], v[124:127], v[188:191], v[88:91]
    ds_read_b128 v[44:47], v136 offset:3072
    buffer_load_dwordx4 v101, s[68:71], s79 offen offset:3072 sc1 lds
    v_mfma_f32_16x16x32_bf16 v[92:95], v[128:131], v[188:191], v[92:95]
    ds_read_b128 v[48:51], v136 offset:4096
    v_mfma_f32_16x16x32_bf16 v[96:99], v[132:135], v[188:191], v[96:99]
    ds_read_b128 v[52:55], v136 offset:5120
    ds_read_b128 v[56:59], v136 offset:6144
    ds_read_b128 v[60:63], v136 offset:7168
    s_waitcnt lgkmcnt(4)
    v_mfma_f32_16x16x32_bf16 v[84:87], v[32:35], v[192:195], v[84:87]
    ds_read_b128 v[104:107], v136 offset:8192
    v_mfma_f32_16x16x32_bf16 v[88:91], v[36:39], v[192:195], v[88:91]
    ds_read_b128 v[108:111], v136 offset:9216
    v_mfma_f32_16x16x32_bf16 v[92:95], v[40:43], v[192:195], v[92:95]
    ds_read_b128 v[112:115], v136 offset:10240
    v_mfma_f32_16x16x32_bf16 v[96:99], v[44:47], v[192:195], v[96:99]
    ds_read_b128 v[116:119], v136 offset:11264
    s_waitcnt lgkmcnt(4)
    v_mfma_f32_16x16x32_bf16 v[84:87], v[48:51], v[196:199], v[84:87]
    ds_read_b128 v[120:123], v136 offset:12288
    v_mfma_f32_16x16x32_bf16 v[88:91], v[52:55], v[196:199], v[88:91]
    ds_read_b128 v[124:127], v136 offset:13312
    v_mfma_f32_16x16x32_bf16 v[92:95], v[56:59], v[196:199], v[92:95]
    ds_read_b128 v[128:131], v136 offset:14336
    v_mfma_f32_16x16x32_bf16 v[96:99], v[60:63], v[196:199], v[96:99]
    ds_read_b128 v[132:135], v136 offset:15360
    s_waitcnt lgkmcnt(4)
    v_mfma_f32_16x16x32_bf16 v[84:87], v[104:107], v[200:203], v[84:87]
    v_mfma_f32_16x16x32_bf16 v[88:91], v[108:111], v[200:203], v[88:91]
    s_waitcnt vmcnt(8) lgkmcnt(0)
    s_barrier
    v_mfma_f32_16x16x32_bf16 v[92:95], v[112:115], v[200:203], v[92:95]
    ds_read_b128 v[32:35], v136 offset:16384
    v_mfma_f32_16x16x32_bf16 v[96:99], v[116:119], v[200:203], v[96:99]
    ds_read_b128 v[36:39], v136 offset:17408
    v_mfma_f32_16x16x32_bf16 v[84:87], v[120:123], v[204:207], v[84:87]
    ds_read_b128 v[40:43], v136 offset:18432
    v_mfma_f32_16x16x32_bf16 v[88:91], v[124:127], v[204:207], v[88:91]
    ds_read_b128 v[44:47], v136 offset:19456
    v_mfma_f32_16x16x32_bf16 v[92:95], v[128:131], v[204:207], v[92:95]
    ds_read_b128 v[48:51], v136 offset:20480
    v_mfma_f32_16x16x32_bf16 v[96:99], v[132:135], v[204:207], v[96:99]
    ds_read_b128 v[52:55], v136 offset:21504
    ds_read_b128 v[56:59], v136 offset:22528
    ds_read_b128 v[60:63], v136 offset:23552
    s_waitcnt lgkmcnt(4)
    v_mfma_f32_16x16x32_bf16 v[84:87], v[32:35], v[208:211], v[84:87]
    ds_read_b128 v[104:107], v136 offset:24576
    v_mfma_f32_16x16x32_bf16 v[88:91], v[36:39], v[208:211], v[88:91]
    ds_read_b128 v[108:111], v136 offset:25600
    v_mfma_f32_16x16x32_bf16 v[92:95], v[40:43], v[208:211], v[92:95]
    ds_read_b128 v[112:115], v136 offset:26624
    v_mfma_f32_16x16x32_bf16 v[96:99], v[44:47], v[208:211], v[96:99]
    ds_read_b128 v[116:119], v136 offset:27648
    s_waitcnt lgkmcnt(4)
    v_mfma_f32_16x16x32_bf16 v[84:87], v[48:51], v[212:215], v[84:87]
    ds_read_b128 v[120:123], v136 offset:28672
    v_mfma_f32_16x16x32_bf16 v[88:91], v[52:55], v[212:215], v[88:91]
    ds_read_b128 v[124:127], v136 offset:29696
    v_mfma_f32_16x16x32_bf16 v[92:95], v[56:59], v[212:215], v[92:95]
    ds_read_b128 v[128:131], v136 offset:30720
    v_mfma_f32_16x16x32_bf16 v[96:99], v[60:63], v[212:215], v[96:99]
    ds_read_b128 v[132:135], v136 offset:31744
    s_waitcnt lgkmcnt(4)
    v_mfma_f32_16x16x32_bf16 v[84:87], v[104:107], v[216:219], v[84:87]
    v_mfma_f32_16x16x32_bf16 v[88:91], v[108:111], v[216:219], v[88:91]
    s_waitcnt vmcnt(4) lgkmcnt(0)
    s_barrier
    v_mfma_f32_16x16x32_bf16 v[92:95], v[112:115], v[216:219], v[92:95]
    ds_read_b128 v[32:35], v101 offset:0
    v_mfma_f32_16x16x32_bf16 v[96:99], v[116:119], v[216:219], v[96:99]
    ds_read_b128 v[36:39], v101 offset:1024
    v_mfma_f32_16x16x32_bf16 v[84:87], v[120:123], v[220:223], v[84:87]
    ds_read_b128 v[40:43], v101 offset:2048
    v_mfma_f32_16x16x32_bf16 v[88:91], v[124:127], v[220:223], v[88:91]
    ds_read_b128 v[44:47], v101 offset:3072
    v_mfma_f32_16x16x32_bf16 v[92:95], v[128:131], v[220:223], v[92:95]
    ds_read_b128 v[48:51], v101 offset:4096
    v_mfma_f32_16x16x32_bf16 v[96:99], v[132:135], v[220:223], v[96:99]
    ds_read_b128 v[52:55], v101 offset:5120
    ds_read_b128 v[56:59], v101 offset:6144
    ds_read_b128 v[60:63], v101 offset:7168
    s_waitcnt lgkmcnt(4)
    v_mfma_f32_16x16x32_bf16 v[84:87], v[32:35], v[224:227], v[84:87]
    ds_read_b128 v[104:107], v101 offset:8192
    v_mfma_f32_16x16x32_bf16 v[88:91], v[36:39], v[224:227], v[88:91]
    ds_read_b128 v[108:111], v101 offset:9216
    v_mfma_f32_16x16x32_bf16 v[92:95], v[40:43], v[224:227], v[92:95]
    ds_read_b128 v[112:115], v101 offset:10240
    v_mfma_f32_16x16x32_bf16 v[96:99], v[44:47], v[224:227], v[96:99]
    ds_read_b128 v[116:119], v101 offset:11264
    s_waitcnt lgkmcnt(4)
    v_mfma_f32_16x16x32_bf16 v[84:87], v[48:51], v[228:231], v[84:87]
    ds_read_b128 v[120:123], v101 offset:12288
    v_mfma_f32_16x16x32_bf16 v[88:91], v[52:55], v[228:231], v[88:91]
    ds_read_b128 v[124:127], v101 offset:13312
    v_mfma_f32_16x16x32_bf16 v[92:95], v[56:59], v[228:231], v[92:95]
    ds_read_b128 v[128:131], v101 offset:14336
    v_mfma_f32_16x16x32_bf16 v[96:99], v[60:63], v[228:231], v[96:99]
    ds_read_b128 v[132:135], v101 offset:15360
    s_waitcnt lgkmcnt(4)
    v_mfma_f32_16x16x32_bf16 v[84:87], v[104:107], v[232:235], v[84:87]
    v_mfma_f32_16x16x32_bf16 v[88:91], v[108:111], v[232:235], v[88:91]
    s_waitcnt vmcnt(0) lgkmcnt(0)
    s_barrier
    v_mfma_f32_16x16x32_bf16 v[92:95], v[112:115], v[232:235], v[92:95]
    ds_read_b128 v[32:35], v101 offset:16384
    v_mfma_f32_16x16x32_bf16 v[96:99], v[116:119], v[232:235], v[96:99]
    ds_read_b128 v[36:39], v101 offset:17408
    v_mfma_f32_16x16x32_bf16 v[84:87], v[120:123], v[236:239], v[84:87]
    ds_read_b128 v[40:43], v101 offset:18432
    v_mfma_f32_16x16x32_bf16 v[88:91], v[124:127], v[236:239], v[88:91]
    ds_read_b128 v[44:47], v101 offset:19456
    v_mfma_f32_16x16x32_bf16 v[92:95], v[128:131], v[236:239], v[92:95]
    ds_read_b128 v[48:51], v101 offset:20480
    v_mfma_f32_16x16x32_bf16 v[96:99], v[132:135], v[236:239], v[96:99]
    ds_read_b128 v[52:55], v101 offset:21504
    ds_read_b128 v[56:59], v101 offset:22528
    ds_read_b128 v[60:63], v101 offset:23552
    s_waitcnt lgkmcnt(4)
    v_mfma_f32_16x16x32_bf16 v[84:87], v[32:35], v[240:243], v[84:87]
    ds_read_b128 v[104:107], v101 offset:24576
    v_mfma_f32_16x16x32_bf16 v[88:91], v[36:39], v[240:243], v[88:91]
    ds_read_b128 v[108:111], v101 offset:25600
    v_mfma_f32_16x16x32_bf16 v[92:95], v[40:43], v[240:243], v[92:95]
    ds_read_b128 v[112:115], v101 offset:26624
    v_mfma_f32_16x16x32_bf16 v[96:99], v[44:47], v[240:243], v[96:99]
    ds_read_b128 v[116:119], v101 offset:27648
    s_waitcnt lgkmcnt(4)
    v_mfma_f32_16x16x32_bf16 v[84:87], v[48:51], v[244:247], v[84:87]
    ds_read_b128 v[120:123], v101 offset:28672
    v_mfma_f32_16x16x32_bf16 v[88:91], v[52:55], v[244:247], v[88:91]
    ds_read_b128 v[124:127], v101 offset:29696
    v_mfma_f32_16x16x32_bf16 v[92:95], v[56:59], v[244:247], v[92:95]
    ds_read_b128 v[128:131], v101 offset:30720
    v_mfma_f32_16x16x32_bf16 v[96:99], v[60:63], v[244:247], v[96:99]
    ds_read_b128 v[132:135], v101 offset:31744
    s_waitcnt lgkmcnt(4)
    v_mfma_f32_16x16x32_bf16 v[84:87], v[104:107], v[248:251], v[84:87]
    v_mfma_f32_16x16x32_bf16 v[88:91], v[108:111], v[248:251], v[88:91]
    v_mfma_f32_16x16x32_bf16 v[92:95], v[112:115], v[248:251], v[92:95]
    v_mfma_f32_16x16x32_bf16 v[96:99], v[116:119], v[248:251], v[96:99]
    s_waitcnt lgkmcnt(0)
    v_mfma_f32_16x16x32_bf16 v[84:87], v[120:123], v[252:255], v[84:87]
    v_mfma_f32_16x16x32_bf16 v[88:91], v[124:127], v[252:255], v[88:91]
    v_mfma_f32_16x16x32_bf16 v[92:95], v[128:131], v[252:255], v[92:95]
    v_mfma_f32_16x16x32_bf16 v[96:99], v[132:135], v[252:255], v[96:99]
    s_mul_i32 s14, s7, 229376
    s_lshl_b32 s15, s6, 8
    s_add_u32 s14, s14, s15
    s_lshl_b32 s15, s9, 6
    s_add_u32 s14, s14, s15
    s_add_u32 s14, s14, 1792
    buffer_store_dword v84, v103, s[60:63], s14 offen nt
    buffer_store_dword v86, v103, s[60:63], s14 offen offset:3584 nt
    s_add_u32 s14, s14, 28672
    buffer_store_dword v85, v103, s[60:63], s14 offen nt
    buffer_store_dword v87, v103, s[60:63], s14 offen offset:3584 nt
    s_add_u32 s14, s14, 28672
    buffer_store_dword v88, v103, s[60:63], s14 offen nt
    buffer_store_dword v90, v103, s[60:63], s14 offen offset:3584 nt
    s_add_u32 s14, s14, 28672
    buffer_store_dword v89, v103, s[60:63], s14 offen nt
    buffer_store_dword v91, v103, s[60:63], s14 offen offset:3584 nt
    s_add_u32 s14, s14, 28672
    buffer_store_dword v92, v103, s[60:63], s14 offen nt
    buffer_store_dword v94, v103, s[60:63], s14 offen offset:3584 nt
    s_add_u32 s14, s14, 28672
    buffer_store_dword v93, v103, s[60:63], s14 offen nt
    buffer_store_dword v95, v103, s[60:63], s14 offen offset:3584 nt
    s_add_u32 s14, s14, 28672
    buffer_store_dword v96, v103, s[60:63], s14 offen nt
    buffer_store_dword v98, v103, s[60:63], s14 offen offset:3584 nt
    s_add_u32 s14, s14, 28672
    buffer_store_dword v97, v103, s[60:63], s14 offen nt
    buffer_store_dword v99, v103, s[60:63], s14 offen offset:3584 nt
    s_add_u32 s14, s14, 28672
    s_endpgm
A_idle:
    s_cmp_lg_u32 s2, 7
    s_cbranch_scc1 L_exit
    s_branch L_prop
B_idle:
    s_waitcnt lgkmcnt(0)
    s_cmp_lg_u32 s4, 28
    s_cbranch_scc1 L_cpf
    s_cmp_lg_u32 s9, 0
    s_cbranch_scc1 L_cpf
L_prop:
    s_waitcnt lgkmcnt(0)
    s_cmp_lg_u32 s9, 0
    s_cbranch_scc1 L_exit
    s_mov_b64 exec, 1
    s_memrealtime s[6:7]
    v_mov_b32 v1, 0
    v_mov_b32 v3, 0
    s_waitcnt lgkmcnt(0)
    s_or_b32 s6, s6, 1
    v_mov_b32 v2, s6
    global_atomic_cmpswap v1, v[2:3], s[36:37] sc1
    s_mov_b64 exec, -1
    s_cmp_lt_u32 s2, 256
    s_cbranch_scc1 L_exit
    v_mbcnt_lo_u32_b32 v1, -1, 0
    v_mbcnt_hi_u32_b32 v1, -1, v1
L_cpf:
    v_lshlrev_b32 v2, 21, v1
    s_mov_b64 exec, 0xf
    global_load_dword v108, v2, s[34:35]
    global_load_dword v109, v2, s[38:39]
    s_mov_b64 exec, -1
    s_and_b32 s5, s2, 7
    s_sub_u32 s3, s4, 28
    s_lshl_b32 s3, s3, 2
    s_add_u32 s3, s3, s9
    s_lshl_b32 s6, s5, 11
    v_and_b32 v2, 31, v1
    v_lshl_add_u32 v2, v2, 6, s6
    v_add_u32 v3, 0xd000, v2
    v_add_u32 v4, 0x9000, v2
    s_lshr_b32 s6, s5, 1
    s_and_b32 s6, s6, 2
    s_lshl_b32 s6, s6, 11
    v_xor_b32 v2, s6, v2
    v_add_u32 v2, 0x1000, v2
    s_cmp_lg_u32 s3, 5
    s_cbranch_scc1 L_nf
    global_load_dword v110, v2, s[38:39]
    global_load_dword v111, v3, s[38:39]
    global_load_dword v112, v4, s[38:39]
L_nf:
    s_branch L_exit
    v_mov_b32 v15, 0
    s_sleep 0
    s_lshr_b32 s6, s5, 1
    s_and_b32 s6, s6, 2
    s_xor_b32 s6, s6, s5
    s_lshl_b32 s6, s6, 4
    s_add_u32 s6, s6, s3
    s_mul_i32 s6, s6, 28672
    s_add_u32 s6, s6, 0x100000
    v_lshl_add_u32 v2, v1, 4, s6
    s_mov_b32 s11, 0
    s_branch L_he
L_hl:
    global_load_dwordx4 v[112:115], v2, s[38:39] nt
    global_load_dwordx4 v[116:119], v2, s[38:39] offset:1024 nt
    v_add_u32 v2, 2048, v2
    s_waitcnt vmcnt(10)
    s_sub_u32 s11, s11, 1
    s_cmp_lg_u32 s11, 0
    s_cbranch_scc1 L_hl
L_he:
    s_sub_u32 s3, s4, 28
    s_lshl_b32 s3, s3, 2
    s_add_u32 s3, s3, s9
    s_and_b32 s5, s2, 7
    s_mul_i32 s5, s5, 49
    s_add_u32 s3, s3, s5
    s_lshl_b32 s3, s3, 10
    v_lshlrev_b32 v2, 4, v1
    s_mov_b32 s11, 0
    s_branch L_ce
L_cl:
    s_add_u32 s6, s26, s3
    s_addc_u32 s7, s27, 0
    global_load_dwordx4 v[112:115], v2, s[6:7]
    s_add_u32 s6, s28, s3
    s_addc_u32 s7, s29, 0
    global_load_dwordx4 v[116:119], v2, s[6:7]
    s_add_u32 s3, s3, 0x4000
    s_sub_u32 s5, s3, 401408
    s_cmp_ge_u32 s3, 401408
    s_cselect_b32 s3, s5, s3
    s_waitcnt vmcnt(10)
    s_sub_u32 s11, s11, 1
    s_cmp_lg_u32 s11, 0
    s_cbranch_scc1 L_cl
L_ce:
L_exit:
    s_endpgm
.p2align 6
L_end:
.section .rodata,"a"
.p2align 6
.amdhsa_kernel concat_heads__ssm_conv_s4d__ssm_conv_s5__prompt_kernel
  .amdhsa_next_free_vgpr 256
  .amdhsa_next_free_sgpr 102
  .amdhsa_accum_offset 256
  .amdhsa_group_segment_fixed_size 0
  .amdhsa_ieee_mode 0
  .amdhsa_kernarg_size 152
  .amdhsa_user_sgpr_count 2
  .amdhsa_user_sgpr_kernarg_segment_ptr 1
  .amdhsa_system_sgpr_workgroup_id_x 1
.end_amdhsa_kernel
```
